```python
import torch

def _softmax(x, axis=-1):
    return torch.softmax(x, dim=axis)
def _gelu(x):
    return torch.nn.functional.gelu(x, approximate="tanh")
def _silu(x):
    return torch.nn.functional.silu(x)
def _sigmoid(x):
    return torch.sigmoid(x)
def _layernorm(x, axis=-1, eps=1e-5):
    m = x.mean(dim=axis, keepdim=True)
    v = x.var(dim=axis, keepdim=True, unbiased=False)
    return (x - m) / torch.sqrt(v + eps)
def _scatter_add(tgt, idx, src, axis=0):
    return tgt.clone().index_add_(axis, idx, src)
def _segment_sum(src, seg, n):
    out = torch.zeros((n,) + src.shape[1:], dtype=src.dtype)
    return out.index_add_(0, seg, src)
def _pad(x, pw):
    flat = tuple(v for pair in reversed(pw) for v in pair)
    return torch.nn.functional.pad(x, flat)

kernel_name = 'concat_heads__mha_block_cached__mha_block_cached__near_ridge'

def setup_inputs():

    _w = (lambda a: (lambda t: t.to(torch.bfloat16) if t.is_floating_point() else t)(torch.as_tensor(a)))
    def _A_setup():
        B, Sq, D = 8, 128, 640
        H, Sk, Dh = 32, 512, 192
        return {
            "x": _w((lambda *s: torch.randn(*s, dtype=torch.bfloat16) * 0.8)(B, Sq, D)),
            "k_cache": _w((lambda *s: torch.randn(*s, dtype=torch.bfloat16) * 0.8)(B, H, Sk, Dh)),
            "v_cache": _w((lambda *s: torch.randn(*s, dtype=torch.bfloat16) * 0.05)(B, H, Sk, Dh)),
            "wq": _w((lambda *s: torch.randn(*s, dtype=torch.bfloat16) * 0.8)(D, H * Dh) * (D ** -0.5)),
            "wo": _w((lambda *s: torch.randn(*s, dtype=torch.bfloat16) * 0.05)(H * Dh, D) * ((H * Dh) ** -0.5)),
        }
    _A_in = _A_setup()

    def _B_setup():
        B, Sq, D = 8, 128, 640
        H, Sk, Dh = 32, 512, 192
        return {
            "x": _w((lambda *s: torch.randn(*s, dtype=torch.bfloat16) * 0.8)(B, Sq, D)),
            "k_cache": _w((lambda *s: torch.randn(*s, dtype=torch.bfloat16) * 0.8)(B, H, Sk, Dh)),
            "v_cache": _w((lambda *s: torch.randn(*s, dtype=torch.bfloat16) * 0.05)(B, H, Sk, Dh)),
            "wq": _w((lambda *s: torch.randn(*s, dtype=torch.bfloat16) * 0.8)(D, H * Dh) * (D ** -0.5)),
            "wo": _w((lambda *s: torch.randn(*s, dtype=torch.bfloat16) * 0.05)(H * Dh, D) * ((H * Dh) ** -0.5)),
        }
    _B_in = _B_setup()

    return {
        "A_x": _A_in["x"],
        "A_k_cache": _A_in["k_cache"],
        "A_v_cache": _A_in["v_cache"],
        "A_wq": _A_in["wq"],
        "A_wo": _A_in["wo"],
        "B_x": _B_in["x"],
        "B_k_cache": _B_in["k_cache"],
        "B_v_cache": _B_in["v_cache"],
        "B_wq": _B_in["wq"],
        "B_wo": _B_in["wo"],
    }

def reference(A_x, A_k_cache, A_v_cache, A_wq, A_wo, B_x, B_k_cache, B_v_cache, B_wq, B_wo):
    def _A_ref(x, k_cache, v_cache, wq, wo):
        B, Sq, D = x.shape
        H, Dh = 32, 192
        q = (lambda x, *d: x.permute(*d))((x @ wq).reshape(B, Sq, H, Dh), 0, 2, 1, 3)
        scores = torch.einsum("bhqd,bhkd->bhqk", q, k_cache) * (Dh ** -0.5)
        p = _softmax(scores, axis=-1)
        o = torch.einsum("bhqk,bhkd->bhqd", p, v_cache)
        return (lambda x, *d: x.permute(*d))(o, 0, 2, 1, 3).reshape(B, Sq, H * Dh) @ wo

    def _B_ref(x, k_cache, v_cache, wq, wo):
        B, Sq, D = x.shape
        H, Dh = 32, 192
        q = (lambda x, *d: x.permute(*d))((x @ wq).reshape(B, Sq, H, Dh), 0, 2, 1, 3)
        scores = torch.einsum("bhqd,bhkd->bhqk", q, k_cache) * (Dh ** -0.5)
        p = _softmax(scores, axis=-1)
        o = torch.einsum("bhqk,bhkd->bhqd", p, v_cache)
        return (lambda x, *d: x.permute(*d))(o, 0, 2, 1, 3).reshape(B, Sq, H * Dh) @ wo

    a = _A_ref(A_x, A_k_cache, A_v_cache, A_wq, A_wo)
    b = _B_ref(B_x, B_k_cache, B_v_cache, B_wq, B_wo)
    return torch.concatenate([a, b], axis=-1)
```

```asm
; @launch kernel=concat_heads__mha_block_cached__mha_block_cached__near_ridge_kernel grid=(256,1,1) block=(512,1,1) lds=163840
; @launch kernel=mha_oproj_kernel grid=(256,1,1) block=(512,1,1) lds=122880
; @launch kernel=mha_comb_kernel grid=(256,1,1) block=(320,1,1) lds=0
.amdgcn_target "amdgcn-amd-amdhsa--gfx950"
.text
.globl concat_heads__mha_block_cached__mha_block_cached__near_ridge_kernel
.p2align 8
.type concat_heads__mha_block_cached__mha_block_cached__near_ridge_kernel,@function
concat_heads__mha_block_cached__mha_block_cached__near_ridge_kernel:
    s_cmp_ge_u32 s2, 256
    s_cbranch_scc1 K1_END
    s_load_dwordx8 s[32:39], s[0:1], 0
    s_load_dwordx8 s[40:47], s[0:1], 40
    s_load_dwordx2 s[54:55], s[0:1], 96
    v_lshrrev_b32 v241, 6, v0
    v_and_b32 v242, 63, v0
    s_nop 0
    v_readfirstlane_b32 s24, v241
    s_lshr_b32 s25, s24, 2
    s_and_b32 s24, s24, 3
    s_and_b32 s56, s2, 7
    s_lshr_b32 s57, s2, 3
    s_lshr_b32 s59, s56, 2
    s_and_b32 s56, s56, 3
    s_lshl_b32 s56, s56, 3
    s_and_b32 s58, s57, 7
    s_add_u32 s56, s56, s58
    s_lshr_b32 s58, s57, 3
    s_and_b32 s58, s58, 3
    s_lshl_b32 s60, s25, 2
    s_add_u32 s58, s58, s60
    s_waitcnt lgkmcnt(0)
    s_cmp_eq_u32 s59, 0
    s_cselect_b64 s[32:33], s[32:33], s[40:41]
    s_cselect_b64 s[34:35], s[34:35], s[42:43]
    s_cselect_b64 s[36:37], s[36:37], s[44:45]
    s_cselect_b64 s[38:39], s[38:39], s[46:47]
    s_mul_i32 s60, s58, 163840
    s_add_u32 s32, s32, s60
    s_addc_u32 s33, s33, 0
    s_mov_b32 s8, s32
    s_and_b32 s9, s33, 0xffff
    s_mov_b32 s10, 163840
    s_mov_b32 s11, 0x20000
    s_lshl_b32 s60, s58, 5
    s_add_u32 s60, s60, s56
    s_mul_i32 s61, s60, 196608
    s_mul_hi_u32 s62, s60, 196608
    s_add_u32 s34, s34, s61
    s_addc_u32 s35, s35, s62
    s_add_u32 s36, s36, s61
    s_addc_u32 s37, s37, s62
    s_mov_b32 s12, s34
    s_and_b32 s13, s35, 0xffff
    s_mov_b32 s14, 196608
    s_mov_b32 s15, 0x20000
    s_mov_b32 s16, s36
    s_and_b32 s17, s37, 0xffff
    s_mov_b32 s18, 196608
    s_mov_b32 s19, 0x20000
    s_mul_i32 s60, s56, 384
    s_add_u32 s38, s38, s60
    s_addc_u32 s39, s39, 0
    s_sub_u32 s61, 7864320, s60
    s_mov_b32 s4, s38
    s_and_b32 s5, s39, 0xffff
    s_mov_b32 s6, s61
    s_mov_b32 s7, 0x20000
    s_lshl_b32 s60, s59, 3
    s_add_u32 s60, s60, s58
    s_lshl_b32 s60, s60, 2
    s_add_u32 s60, s60, s24
    s_mul_i32 s60, s60, 393216
    s_mul_i32 s61, s56, 12288
    s_add_u32 s60, s60, s61
    s_add_u32 s54, s54, s60
    s_addc_u32 s55, s55, 0
    s_mov_b32 s20, s54
    s_and_b32 s21, s55, 0xffff
    s_mov_b32 s22, 12288
    s_mov_b32 s23, 0x20000
    s_mul_i32 s49, s24, 3072
    s_lshl_b32 s50, s24, 11
    s_add_u32 s50, s50, 12288
    s_mul_i32 s30, s24, 98304
    s_mul_i32 s31, s24, 40960
    s_mov_b32 s48, s49
    s_mov_b32 s26, 0
    s_mov_b32 s27, 24576
    s_mov_b32 s28, 49152
    s_lshl_b32 s60, s25, 13
    s_add_u32 s50, s50, s60
    s_mul_i32 s26, s25, 24576
    s_add_u32 s26, s26, 114688
    s_mul_i32 s27, s25, 28672
    s_add_u32 s28, s27, 57344
    s_mov_b32 s51, 0x3dd53b95
    s_and_b32 s60, s24, 1
    s_lshl_b32 s60, s60, 2
    v_mov_b32 v243, v242
    v_mul_u32_u24 v244, 2731, v243
    v_lshrrev_b32 v244, 16, v244
    v_mul_u32_u24 v245, 24, v244
    v_sub_u32 v245, v243, v245
    v_lshrrev_b32 v246, 1, v244
    v_add_u32 v247, s60, v246
    v_xor_b32 v247, v247, v245
    v_lshlrev_b32 v247, 4, v247
    v_mul_u32_u24 v248, 384, v244
    v_add_u32 v216, v247, v248
    v_and_b32 v246, 1, v246
    v_lshlrev_b32 v246, 2, v246
    v_xor_b32 v246, v246, v245
    v_lshlrev_b32 v246, 4, v246
    v_add_u32 v219, v246, v248
    v_mul_u32_u24 v248, 12288, v244
    v_add_u32 v96, v246, v248
    v_add_u32 v243, 64, v242
    v_mul_u32_u24 v244, 2731, v243
    v_lshrrev_b32 v244, 16, v244
    v_mul_u32_u24 v245, 24, v244
    v_sub_u32 v245, v243, v245
    v_lshrrev_b32 v246, 1, v244
    v_add_u32 v247, s60, v246
    v_xor_b32 v247, v247, v245
    v_lshlrev_b32 v247, 4, v247
    v_mul_u32_u24 v248, 384, v244
    v_add_u32 v217, v247, v248
    v_and_b32 v246, 1, v246
    v_lshlrev_b32 v246, 2, v246
    v_xor_b32 v246, v246, v245
    v_lshlrev_b32 v246, 4, v246
    v_add_u32 v220, v246, v248
    v_mul_u32_u24 v248, 12288, v244
    v_add_u32 v97, v246, v248
    v_add_u32 v243, 128, v242
    v_mul_u32_u24 v244, 2731, v243
    v_lshrrev_b32 v244, 16, v244
    v_mul_u32_u24 v245, 24, v244
    v_sub_u32 v245, v243, v245
    v_lshrrev_b32 v246, 1, v244
    v_add_u32 v247, s60, v246
    v_xor_b32 v247, v247, v245
    v_lshlrev_b32 v247, 4, v247
    v_mul_u32_u24 v248, 384, v244
    v_add_u32 v218, v247, v248
    v_and_b32 v246, 1, v246
    v_lshlrev_b32 v246, 2, v246
    v_xor_b32 v246, v246, v245
    v_lshlrev_b32 v246, 4, v246
    v_add_u32 v221, v246, v248
    v_mul_u32_u24 v248, 12288, v244
    v_add_u32 v98, v246, v248
    v_lshrrev_b32 v243, 2, v242
    v_mul_u32_u24 v243, 1280, v243
    v_lshrrev_b32 v244, 4, v242
    v_xor_b32 v244, v244, v242
    v_and_b32 v244, 3, v244
    v_lshlrev_b32 v244, 4, v244
    v_add_u32 v99, v243, v244
    s_add_u32 s52, s26, s49
    s_add_u32 m0, s52, 0
    s_nop 0
    buffer_load_dwordx4 v216, s[12:15], s48 offen nt lds
    s_add_u32 m0, s52, 1024
    s_nop 0
    buffer_load_dwordx4 v217, s[12:15], s48 offen nt lds
    s_add_u32 m0, s52, 2048
    s_nop 0
    buffer_load_dwordx4 v218, s[12:15], s48 offen nt lds
    s_add_u32 s52, s26, s49
    s_add_u32 s52, s52, 12288
    s_add_u32 s53, s48, 12288
    s_add_u32 m0, s52, 0
    s_nop 0
    buffer_load_dwordx4 v216, s[12:15], s53 offen nt lds
    s_add_u32 m0, s52, 1024
    s_nop 0
    buffer_load_dwordx4 v217, s[12:15], s53 offen nt lds
    s_add_u32 m0, s52, 2048
    s_nop 0
    buffer_load_dwordx4 v218, s[12:15], s53 offen nt lds
    s_cmp_eq_u32 s25, 0
    s_cbranch_scc1 K1_PROA
    s_branch K1_PROB
K1_PROA:
    s_add_u32 m0, s49, 0
    s_nop 0
    buffer_load_dwordx4 v96, s[4:7], s30 offen lds
    s_add_u32 m0, s49, 1024
    s_nop 0
    buffer_load_dwordx4 v97, s[4:7], s30 offen lds
    s_add_u32 m0, s50, 0
    s_nop 0
    buffer_load_dwordx4 v99, s[8:11], s31 offen lds
    s_add_u32 m0, s50, 1024
    s_add_u32 s52, s31, 20480
    buffer_load_dwordx4 v99, s[8:11], s52 offen lds
    s_add_u32 s30, s30, 393216
    s_add_u32 s31, s31, 64
    s_add_u32 m0, s49, 28672
    s_nop 0
    buffer_load_dwordx4 v96, s[4:7], s30 offen lds
    s_add_u32 m0, s49, 29696
    s_nop 0
    buffer_load_dwordx4 v97, s[4:7], s30 offen lds
    s_add_u32 m0, s50, 28672
    s_nop 0
    buffer_load_dwordx4 v99, s[8:11], s31 offen lds
    s_add_u32 m0, s50, 29696
    s_add_u32 s52, s31, 20480
    buffer_load_dwordx4 v99, s[8:11], s52 offen lds
    s_add_u32 s30, s30, 393216
    s_add_u32 s31, s31, 64
    s_add_u32 m0, s49, 57344
    s_nop 0
    buffer_load_dwordx4 v96, s[4:7], s30 offen lds
    s_add_u32 m0, s49, 58368
    s_nop 0
    buffer_load_dwordx4 v97, s[4:7], s30 offen lds
    s_add_u32 m0, s50, 57344
    s_nop 0
    buffer_load_dwordx4 v99, s[8:11], s31 offen lds
    s_add_u32 m0, s50, 58368
    s_add_u32 s52, s31, 20480
    buffer_load_dwordx4 v99, s[8:11], s52 offen lds
    s_add_u32 s30, s30, 393216
    s_add_u32 s31, s31, 64
    s_branch K1_PROE
K1_PROB:
    s_add_u32 m0, s49, 2048
    s_nop 0
    buffer_load_dwordx4 v98, s[4:7], s30 offen lds
    s_add_u32 m0, s50, 0
    s_nop 0
    buffer_load_dwordx4 v99, s[8:11], s31 offen lds
    s_add_u32 m0, s50, 1024
    s_add_u32 s52, s31, 20480
    buffer_load_dwordx4 v99, s[8:11], s52 offen lds
    s_add_u32 s30, s30, 393216
    s_add_u32 s31, s31, 64
    s_add_u32 m0, s49, 30720
    s_nop 0
    buffer_load_dwordx4 v98, s[4:7], s30 offen lds
    s_add_u32 m0, s50, 28672
    s_nop 0
    buffer_load_dwordx4 v99, s[8:11], s31 offen lds
    s_add_u32 m0, s50, 29696
    s_add_u32 s52, s31, 20480
    buffer_load_dwordx4 v99, s[8:11], s52 offen lds
    s_add_u32 s30, s30, 393216
    s_add_u32 s31, s31, 64
    s_add_u32 m0, s49, 59392
    s_nop 0
    buffer_load_dwordx4 v98, s[4:7], s30 offen lds
    s_add_u32 m0, s50, 57344
    s_nop 0
    buffer_load_dwordx4 v99, s[8:11], s31 offen lds
    s_add_u32 m0, s50, 58368
    s_add_u32 s52, s31, 20480
    buffer_load_dwordx4 v99, s[8:11], s52 offen lds
    s_add_u32 s30, s30, 393216
    s_add_u32 s31, s31, 64
    s_branch K1_PROE
K1_PROE:
    v_and_b32 v243, 31, v242
    v_lshrrev_b32 v244, 5, v242
    v_bfe_u32 v245, v242, 2, 2
    v_and_b32 v246, 3, v242
    v_bfe_u32 v247, v242, 4, 1
    v_bfe_u32 v248, v242, 3, 1
    v_lshlrev_b32 v255, 2, v244
    v_add_u32 v255, v255, v245
    v_mul_u32_u24 v255, 384, v255
    v_lshlrev_b32 v254, 5, v247
    v_add_u32 v255, v255, v254
    v_lshlrev_b32 v192, 3, v246
    v_add_u32 v255, v255, v192
    v_lshlrev_b32 v192, 6, v248
    v_add_u32 v230, v255, v192
    v_sub_u32 v231, v255, v192
    v_lshlrev_b32 v255, 3, v244
    v_add_u32 v255, v255, v245
    v_mul_u32_u24 v255, 384, v255
    v_add_u32 v255, v255, v254
    v_and_b32 v193, 1, v246
    v_lshlrev_b32 v193, 4, v193
    v_lshrrev_b32 v194, 1, v246
    v_lshlrev_b32 v194, 3, v194
    v_add_u32 v255, v255, v193
    v_add_u32 v255, v255, v194
    v_add_u32 v100, v255, v192
    v_sub_u32 v101, v255, v192
    v_bfe_u32 v255, v243, 2, 2
    v_xor_b32 v255, v255, v244
    v_lshlrev_b32 v255, 4, v255
    v_lshlrev_b32 v254, 6, v243
    v_add_u32 v254, s50, v254
    v_add_u32 v104, v254, v255
    v_xor_b32 v255, 32, v255
    v_add_u32 v105, v254, v255
    v_bfe_u32 v255, v243, 1, 3
    v_xor_b32 v255, v255, v244
    v_lshlrev_b32 v255, 4, v255
    v_mul_u32_u24 v254, 384, v243
    v_xor_b32 v192, 0, v255
    v_add_u32 v222, v254, v192
    v_xor_b32 v192, 32, v255
    v_add_u32 v223, v254, v192
    v_xor_b32 v192, 64, v255
    v_add_u32 v224, v254, v192
    v_xor_b32 v192, 96, v255
    v_add_u32 v225, v254, v192
    v_mov_b32 v0, 0
    v_mov_b32 v1, 0
    v_mov_b32 v2, 0
    v_mov_b32 v3, 0
    v_mov_b32 v4, 0
    v_mov_b32 v5, 0
    v_mov_b32 v6, 0
    v_mov_b32 v7, 0
    v_mov_b32 v8, 0
    v_mov_b32 v9, 0
    v_mov_b32 v10, 0
    v_mov_b32 v11, 0
    v_mov_b32 v12, 0
    v_mov_b32 v13, 0
    v_mov_b32 v14, 0
    v_mov_b32 v15, 0
    v_mov_b32 v16, 0
    v_mov_b32 v17, 0
    v_mov_b32 v18, 0
    v_mov_b32 v19, 0
    v_mov_b32 v20, 0
    v_mov_b32 v21, 0
    v_mov_b32 v22, 0
    v_mov_b32 v23, 0
    v_mov_b32 v24, 0
    v_mov_b32 v25, 0
    v_mov_b32 v26, 0
    v_mov_b32 v27, 0
    v_mov_b32 v28, 0
    v_mov_b32 v29, 0
    v_mov_b32 v30, 0
    v_mov_b32 v31, 0
    v_mov_b32 v32, 0
    v_mov_b32 v33, 0
    v_mov_b32 v34, 0
    v_mov_b32 v35, 0
    v_mov_b32 v36, 0
    v_mov_b32 v37, 0
    v_mov_b32 v38, 0
    v_mov_b32 v39, 0
    v_mov_b32 v40, 0
    v_mov_b32 v41, 0
    v_mov_b32 v42, 0
    v_mov_b32 v43, 0
    v_mov_b32 v44, 0
    v_mov_b32 v45, 0
    v_mov_b32 v46, 0
    v_mov_b32 v47, 0
    v_mov_b32 v48, 0
    v_mov_b32 v49, 0
    v_mov_b32 v50, 0
    v_mov_b32 v51, 0
    v_mov_b32 v52, 0
    v_mov_b32 v53, 0
    v_mov_b32 v54, 0
    v_mov_b32 v55, 0
    v_mov_b32 v56, 0
    v_mov_b32 v57, 0
    v_mov_b32 v58, 0
    v_mov_b32 v59, 0
    v_mov_b32 v60, 0
    v_mov_b32 v61, 0
    v_mov_b32 v62, 0
    v_mov_b32 v63, 0
    v_mov_b32 v64, 0
    v_mov_b32 v65, 0
    v_mov_b32 v66, 0
    v_mov_b32 v67, 0
    v_mov_b32 v68, 0
    v_mov_b32 v69, 0
    v_mov_b32 v70, 0
    v_mov_b32 v71, 0
    v_mov_b32 v72, 0
    v_mov_b32 v73, 0
    v_mov_b32 v74, 0
    v_mov_b32 v75, 0
    v_mov_b32 v76, 0
    v_mov_b32 v77, 0
    v_mov_b32 v78, 0
    v_mov_b32 v79, 0
    v_mov_b32 v80, 0
    v_mov_b32 v81, 0
    v_mov_b32 v82, 0
    v_mov_b32 v83, 0
    v_mov_b32 v84, 0
    v_mov_b32 v85, 0
    v_mov_b32 v86, 0
    v_mov_b32 v87, 0
    v_mov_b32 v88, 0
    v_mov_b32 v89, 0
    v_mov_b32 v90, 0
    v_mov_b32 v91, 0
    v_mov_b32 v92, 0
    v_mov_b32 v93, 0
    v_mov_b32 v94, 0
    v_mov_b32 v95, 0
    s_cmp_eq_u32 s25, 0
    s_cbranch_scc1 K1_QA
    s_branch K1_QB
K1_QA:
    s_mov_b32 s29, 4
K1_QLOOPA:
    s_waitcnt vmcnt(8)
    s_barrier
    v_add_u32 v102, 0, v100
    v_add_u32 v106, 0, v104
    v_add_u32 v103, 0, v101
    v_add_u32 v107, 0, v105
    ds_read_b128 v[160:163], v106
    ds_read_b128 v[164:167], v107
    ds_read_b64_tr_b16 v[112:113], v102 offset:0
    ds_read_b64_tr_b16 v[114:115], v102 offset:1536
    ds_read_b64_tr_b16 v[116:117], v103 offset:64
    ds_read_b64_tr_b16 v[118:119], v103 offset:1600
    ds_read_b64_tr_b16 v[120:121], v102 offset:128
    ds_read_b64_tr_b16 v[122:123], v102 offset:1664
    ds_read_b64_tr_b16 v[124:125], v103 offset:192
    ds_read_b64_tr_b16 v[126:127], v103 offset:1728
    ds_read_b64_tr_b16 v[128:129], v102 offset:256
    ds_read_b64_tr_b16 v[130:131], v102 offset:1792
    ds_read_b64_tr_b16 v[132:133], v103 offset:320
    ds_read_b64_tr_b16 v[134:135], v103 offset:1856
    s_waitcnt lgkmcnt(10)
    v_mfma_f32_32x32x16_bf16 v[0:15], v[112:115], v[160:163], v[0:15]
    ds_read_b64_tr_b16 v[136:137], v102 offset:6144
    ds_read_b64_tr_b16 v[138:139], v102 offset:7680
    s_add_u32 m0, s49, 86016
    s_nop 0
    buffer_load_dwordx4 v96, s[4:7], s30 offen lds
    s_waitcnt lgkmcnt(10)
    v_mfma_f32_32x32x16_bf16 v[16:31], v[116:119], v[160:163], v[16:31]
    ds_read_b64_tr_b16 v[140:141], v103 offset:6208
    ds_read_b64_tr_b16 v[142:143], v103 offset:7744
    s_waitcnt lgkmcnt(10)
    v_mfma_f32_32x32x16_bf16 v[32:47], v[120:123], v[160:163], v[32:47]
    ds_read_b64_tr_b16 v[112:113], v102 offset:6272
    ds_read_b64_tr_b16 v[114:115], v102 offset:7808
    s_add_u32 m0, s49, 87040
    s_nop 0
    buffer_load_dwordx4 v97, s[4:7], s30 offen lds
    s_waitcnt lgkmcnt(10)
    v_mfma_f32_32x32x16_bf16 v[48:63], v[124:127], v[160:163], v[48:63]
    ds_read_b64_tr_b16 v[116:117], v103 offset:6336
    ds_read_b64_tr_b16 v[118:119], v103 offset:7872
    s_waitcnt lgkmcnt(10)
    v_mfma_f32_32x32x16_bf16 v[64:79], v[128:131], v[160:163], v[64:79]
    ds_read_b64_tr_b16 v[120:121], v102 offset:6400
    ds_read_b64_tr_b16 v[122:123], v102 offset:7936
    s_add_u32 m0, s50, 86016
    s_nop 0
    buffer_load_dwordx4 v99, s[8:11], s31 offen lds
    s_waitcnt lgkmcnt(10)
    v_mfma_f32_32x32x16_bf16 v[80:95], v[132:135], v[160:163], v[80:95]
    ds_read_b64_tr_b16 v[124:125], v103 offset:6464
    ds_read_b64_tr_b16 v[126:127], v103 offset:8000
    s_waitcnt lgkmcnt(10)
    v_mfma_f32_32x32x16_bf16 v[0:15], v[136:139], v[164:167], v[0:15]
    s_add_u32 m0, s50, 87040
    s_add_u32 s52, s31, 20480
    buffer_load_dwordx4 v99, s[8:11], s52 offen lds
    s_add_u32 s30, s30, 393216
    s_add_u32 s31, s31, 64
    s_waitcnt lgkmcnt(8)
    v_mfma_f32_32x32x16_bf16 v[16:31], v[140:143], v[164:167], v[16:31]
    s_waitcnt lgkmcnt(6)
    v_mfma_f32_32x32x16_bf16 v[32:47], v[112:115], v[164:167], v[32:47]
    s_waitcnt lgkmcnt(4)
    v_mfma_f32_32x32x16_bf16 v[48:63], v[116:119], v[164:167], v[48:63]
    s_waitcnt lgkmcnt(2)
    v_mfma_f32_32x32x16_bf16 v[64:79], v[120:123], v[164:167], v[64:79]
    s_waitcnt lgkmcnt(0)
    v_mfma_f32_32x32x16_bf16 v[80:95], v[124:127], v[164:167], v[80:95]
    s_waitcnt vmcnt(8)
    s_barrier
    v_add_u32 v102, 28672, v100
    v_add_u32 v106, 28672, v104
    v_add_u32 v103, 28672, v101
    v_add_u32 v107, 28672, v105
    ds_read_b128 v[160:163], v106
    ds_read_b128 v[164:167], v107
    ds_read_b64_tr_b16 v[112:113], v102 offset:0
    ds_read_b64_tr_b16 v[114:115], v102 offset:1536
    ds_read_b64_tr_b16 v[116:117], v103 offset:64
    ds_read_b64_tr_b16 v[118:119], v103 offset:1600
    ds_read_b64_tr_b16 v[120:121], v102 offset:128
    ds_read_b64_tr_b16 v[122:123], v102 offset:1664
    ds_read_b64_tr_b16 v[124:125], v103 offset:192
    ds_read_b64_tr_b16 v[126:127], v103 offset:1728
    ds_read_b64_tr_b16 v[128:129], v102 offset:256
    ds_read_b64_tr_b16 v[130:131], v102 offset:1792
    ds_read_b64_tr_b16 v[132:133], v103 offset:320
    ds_read_b64_tr_b16 v[134:135], v103 offset:1856
    s_waitcnt lgkmcnt(10)
    v_mfma_f32_32x32x16_bf16 v[0:15], v[112:115], v[160:163], v[0:15]
    ds_read_b64_tr_b16 v[136:137], v102 offset:6144
    ds_read_b64_tr_b16 v[138:139], v102 offset:7680
    s_add_u32 m0, s49, 0
    s_nop 0
    buffer_load_dwordx4 v96, s[4:7], s30 offen lds
    s_waitcnt lgkmcnt(10)
    v_mfma_f32_32x32x16_bf16 v[16:31], v[116:119], v[160:163], v[16:31]
    ds_read_b64_tr_b16 v[140:141], v103 offset:6208
    ds_read_b64_tr_b16 v[142:143], v103 offset:7744
    s_waitcnt lgkmcnt(10)
    v_mfma_f32_32x32x16_bf16 v[32:47], v[120:123], v[160:163], v[32:47]
    ds_read_b64_tr_b16 v[112:113], v102 offset:6272
    ds_read_b64_tr_b16 v[114:115], v102 offset:7808
    s_add_u32 m0, s49, 1024
    s_nop 0
    buffer_load_dwordx4 v97, s[4:7], s30 offen lds
    s_waitcnt lgkmcnt(10)
    v_mfma_f32_32x32x16_bf16 v[48:63], v[124:127], v[160:163], v[48:63]
    ds_read_b64_tr_b16 v[116:117], v103 offset:6336
    ds_read_b64_tr_b16 v[118:119], v103 offset:7872
    s_waitcnt lgkmcnt(10)
    v_mfma_f32_32x32x16_bf16 v[64:79], v[128:131], v[160:163], v[64:79]
    ds_read_b64_tr_b16 v[120:121], v102 offset:6400
    ds_read_b64_tr_b16 v[122:123], v102 offset:7936
    s_add_u32 m0, s50, 0
    s_nop 0
    buffer_load_dwordx4 v99, s[8:11], s31 offen lds
    s_waitcnt lgkmcnt(10)
    v_mfma_f32_32x32x16_bf16 v[80:95], v[132:135], v[160:163], v[80:95]
    ds_read_b64_tr_b16 v[124:125], v103 offset:6464
    ds_read_b64_tr_b16 v[126:127], v103 offset:8000
    s_waitcnt lgkmcnt(10)
    v_mfma_f32_32x32x16_bf16 v[0:15], v[136:139], v[164:167], v[0:15]
    s_add_u32 m0, s50, 1024
    s_add_u32 s52, s31, 20480
    buffer_load_dwordx4 v99, s[8:11], s52 offen lds
    s_add_u32 s30, s30, 393216
    s_add_u32 s31, s31, 64
    s_waitcnt lgkmcnt(8)
    v_mfma_f32_32x32x16_bf16 v[16:31], v[140:143], v[164:167], v[16:31]
    s_waitcnt lgkmcnt(6)
    v_mfma_f32_32x32x16_bf16 v[32:47], v[112:115], v[164:167], v[32:47]
    s_waitcnt lgkmcnt(4)
    v_mfma_f32_32x32x16_bf16 v[48:63], v[116:119], v[164:167], v[48:63]
    s_waitcnt lgkmcnt(2)
    v_mfma_f32_32x32x16_bf16 v[64:79], v[120:123], v[164:167], v[64:79]
    s_waitcnt lgkmcnt(0)
    v_mfma_f32_32x32x16_bf16 v[80:95], v[124:127], v[164:167], v[80:95]
    s_waitcnt vmcnt(8)
    s_barrier
    v_add_u32 v102, 57344, v100
    v_add_u32 v106, 57344, v104
    v_add_u32 v103, 57344, v101
    v_add_u32 v107, 57344, v105
    ds_read_b128 v[160:163], v106
    ds_read_b128 v[164:167], v107
    ds_read_b64_tr_b16 v[112:113], v102 offset:0
    ds_read_b64_tr_b16 v[114:115], v102 offset:1536
    ds_read_b64_tr_b16 v[116:117], v103 offset:64
    ds_read_b64_tr_b16 v[118:119], v103 offset:1600
    ds_read_b64_tr_b16 v[120:121], v102 offset:128
    ds_read_b64_tr_b16 v[122:123], v102 offset:1664
    ds_read_b64_tr_b16 v[124:125], v103 offset:192
    ds_read_b64_tr_b16 v[126:127], v103 offset:1728
    ds_read_b64_tr_b16 v[128:129], v102 offset:256
    ds_read_b64_tr_b16 v[130:131], v102 offset:1792
    ds_read_b64_tr_b16 v[132:133], v103 offset:320
    ds_read_b64_tr_b16 v[134:135], v103 offset:1856
    s_waitcnt lgkmcnt(10)
    v_mfma_f32_32x32x16_bf16 v[0:15], v[112:115], v[160:163], v[0:15]
    ds_read_b64_tr_b16 v[136:137], v102 offset:6144
    ds_read_b64_tr_b16 v[138:139], v102 offset:7680
    s_add_u32 m0, s49, 28672
    s_nop 0
    buffer_load_dwordx4 v96, s[4:7], s30 offen lds
    s_waitcnt lgkmcnt(10)
    v_mfma_f32_32x32x16_bf16 v[16:31], v[116:119], v[160:163], v[16:31]
    ds_read_b64_tr_b16 v[140:141], v103 offset:6208
    ds_read_b64_tr_b16 v[142:143], v103 offset:7744
    s_waitcnt lgkmcnt(10)
    v_mfma_f32_32x32x16_bf16 v[32:47], v[120:123], v[160:163], v[32:47]
    ds_read_b64_tr_b16 v[112:113], v102 offset:6272
    ds_read_b64_tr_b16 v[114:115], v102 offset:7808
    s_add_u32 m0, s49, 29696
    s_nop 0
    buffer_load_dwordx4 v97, s[4:7], s30 offen lds
    s_waitcnt lgkmcnt(10)
    v_mfma_f32_32x32x16_bf16 v[48:63], v[124:127], v[160:163], v[48:63]
    ds_read_b64_tr_b16 v[116:117], v103 offset:6336
    ds_read_b64_tr_b16 v[118:119], v103 offset:7872
    s_waitcnt lgkmcnt(10)
    v_mfma_f32_32x32x16_bf16 v[64:79], v[128:131], v[160:163], v[64:79]
    ds_read_b64_tr_b16 v[120:121], v102 offset:6400
    ds_read_b64_tr_b16 v[122:123], v102 offset:7936
    s_add_u32 m0, s50, 28672
    s_nop 0
    buffer_load_dwordx4 v99, s[8:11], s31 offen lds
    s_waitcnt lgkmcnt(10)
    v_mfma_f32_32x32x16_bf16 v[80:95], v[132:135], v[160:163], v[80:95]
    ds_read_b64_tr_b16 v[124:125], v103 offset:6464
    ds_read_b64_tr_b16 v[126:127], v103 offset:8000
    s_waitcnt lgkmcnt(10)
    v_mfma_f32_32x32x16_bf16 v[0:15], v[136:139], v[164:167], v[0:15]
    s_add_u32 m0, s50, 29696
    s_add_u32 s52, s31, 20480
    buffer_load_dwordx4 v99, s[8:11], s52 offen lds
    s_add_u32 s30, s30, 393216
    s_add_u32 s31, s31, 64
    s_waitcnt lgkmcnt(8)
    v_mfma_f32_32x32x16_bf16 v[16:31], v[140:143], v[164:167], v[16:31]
    s_waitcnt lgkmcnt(6)
    v_mfma_f32_32x32x16_bf16 v[32:47], v[112:115], v[164:167], v[32:47]
    s_waitcnt lgkmcnt(4)
    v_mfma_f32_32x32x16_bf16 v[48:63], v[116:119], v[164:167], v[48:63]
    s_waitcnt lgkmcnt(2)
    v_mfma_f32_32x32x16_bf16 v[64:79], v[120:123], v[164:167], v[64:79]
    s_waitcnt lgkmcnt(0)
    v_mfma_f32_32x32x16_bf16 v[80:95], v[124:127], v[164:167], v[80:95]
    s_waitcnt vmcnt(8)
    s_barrier
    v_add_u32 v102, 86016, v100
    v_add_u32 v106, 86016, v104
    v_add_u32 v103, 86016, v101
    v_add_u32 v107, 86016, v105
    ds_read_b128 v[160:163], v106
    ds_read_b128 v[164:167], v107
    ds_read_b64_tr_b16 v[112:113], v102 offset:0
    ds_read_b64_tr_b16 v[114:115], v102 offset:1536
    ds_read_b64_tr_b16 v[116:117], v103 offset:64
    ds_read_b64_tr_b16 v[118:119], v103 offset:1600
    ds_read_b64_tr_b16 v[120:121], v102 offset:128
    ds_read_b64_tr_b16 v[122:123], v102 offset:1664
    ds_read_b64_tr_b16 v[124:125], v103 offset:192
    ds_read_b64_tr_b16 v[126:127], v103 offset:1728
    ds_read_b64_tr_b16 v[128:129], v102 offset:256
    ds_read_b64_tr_b16 v[130:131], v102 offset:1792
    ds_read_b64_tr_b16 v[132:133], v103 offset:320
    ds_read_b64_tr_b16 v[134:135], v103 offset:1856
    s_waitcnt lgkmcnt(10)
    v_mfma_f32_32x32x16_bf16 v[0:15], v[112:115], v[160:163], v[0:15]
    ds_read_b64_tr_b16 v[136:137], v102 offset:6144
    ds_read_b64_tr_b16 v[138:139], v102 offset:7680
    s_add_u32 m0, s49, 57344
    s_nop 0
    buffer_load_dwordx4 v96, s[4:7], s30 offen lds
    s_waitcnt lgkmcnt(10)
    v_mfma_f32_32x32x16_bf16 v[16:31], v[116:119], v[160:163], v[16:31]
    ds_read_b64_tr_b16 v[140:141], v103 offset:6208
    ds_read_b64_tr_b16 v[142:143], v103 offset:7744
    s_waitcnt lgkmcnt(10)
    v_mfma_f32_32x32x16_bf16 v[32:47], v[120:123], v[160:163], v[32:47]
    ds_read_b64_tr_b16 v[112:113], v102 offset:6272
    ds_read_b64_tr_b16 v[114:115], v102 offset:7808
    s_add_u32 m0, s49, 58368
    s_nop 0
    buffer_load_dwordx4 v97, s[4:7], s30 offen lds
    s_waitcnt lgkmcnt(10)
    v_mfma_f32_32x32x16_bf16 v[48:63], v[124:127], v[160:163], v[48:63]
    ds_read_b64_tr_b16 v[116:117], v103 offset:6336
    ds_read_b64_tr_b16 v[118:119], v103 offset:7872
    s_waitcnt lgkmcnt(10)
    v_mfma_f32_32x32x16_bf16 v[64:79], v[128:131], v[160:163], v[64:79]
    ds_read_b64_tr_b16 v[120:121], v102 offset:6400
    ds_read_b64_tr_b16 v[122:123], v102 offset:7936
    s_add_u32 m0, s50, 57344
    s_nop 0
    buffer_load_dwordx4 v99, s[8:11], s31 offen lds
    s_waitcnt lgkmcnt(10)
    v_mfma_f32_32x32x16_bf16 v[80:95], v[132:135], v[160:163], v[80:95]
    ds_read_b64_tr_b16 v[124:125], v103 offset:6464
    ds_read_b64_tr_b16 v[126:127], v103 offset:8000
    s_waitcnt lgkmcnt(10)
    v_mfma_f32_32x32x16_bf16 v[0:15], v[136:139], v[164:167], v[0:15]
    s_add_u32 m0, s50, 58368
    s_add_u32 s52, s31, 20480
    buffer_load_dwordx4 v99, s[8:11], s52 offen lds
    s_add_u32 s30, s30, 393216
    s_add_u32 s31, s31, 64
    s_waitcnt lgkmcnt(8)
    v_mfma_f32_32x32x16_bf16 v[16:31], v[140:143], v[164:167], v[16:31]
    s_waitcnt lgkmcnt(6)
    v_mfma_f32_32x32x16_bf16 v[32:47], v[112:115], v[164:167], v[32:47]
    s_waitcnt lgkmcnt(4)
    v_mfma_f32_32x32x16_bf16 v[48:63], v[116:119], v[164:167], v[48:63]
    s_waitcnt lgkmcnt(2)
    v_mfma_f32_32x32x16_bf16 v[64:79], v[120:123], v[164:167], v[64:79]
    s_waitcnt lgkmcnt(0)
    v_mfma_f32_32x32x16_bf16 v[80:95], v[124:127], v[164:167], v[80:95]
    s_sub_u32 s29, s29, 1
    s_cmp_lg_u32 s29, 0
    s_cbranch_scc1 K1_QLOOPA
    s_waitcnt vmcnt(8)
    s_barrier
    v_add_u32 v102, 0, v100
    v_add_u32 v106, 0, v104
    v_add_u32 v103, 0, v101
    v_add_u32 v107, 0, v105
    ds_read_b128 v[160:163], v106
    ds_read_b128 v[164:167], v107
    ds_read_b64_tr_b16 v[112:113], v102 offset:0
    ds_read_b64_tr_b16 v[114:115], v102 offset:1536
    ds_read_b64_tr_b16 v[116:117], v103 offset:64
    ds_read_b64_tr_b16 v[118:119], v103 offset:1600
    ds_read_b64_tr_b16 v[120:121], v102 offset:128
    ds_read_b64_tr_b16 v[122:123], v102 offset:1664
    ds_read_b64_tr_b16 v[124:125], v103 offset:192
    ds_read_b64_tr_b16 v[126:127], v103 offset:1728
    ds_read_b64_tr_b16 v[128:129], v102 offset:256
    ds_read_b64_tr_b16 v[130:131], v102 offset:1792
    ds_read_b64_tr_b16 v[132:133], v103 offset:320
    ds_read_b64_tr_b16 v[134:135], v103 offset:1856
    s_waitcnt lgkmcnt(10)
    v_mfma_f32_32x32x16_bf16 v[0:15], v[112:115], v[160:163], v[0:15]
    ds_read_b64_tr_b16 v[136:137], v102 offset:6144
    ds_read_b64_tr_b16 v[138:139], v102 offset:7680
    s_add_u32 m0, s49, 86016
    s_nop 0
    buffer_load_dwordx4 v96, s[4:7], s30 offen lds
    s_waitcnt lgkmcnt(10)
    v_mfma_f32_32x32x16_bf16 v[16:31], v[116:119], v[160:163], v[16:31]
    ds_read_b64_tr_b16 v[140:141], v103 offset:6208
    ds_read_b64_tr_b16 v[142:143], v103 offset:7744
    s_waitcnt lgkmcnt(10)
    v_mfma_f32_32x32x16_bf16 v[32:47], v[120:123], v[160:163], v[32:47]
    ds_read_b64_tr_b16 v[112:113], v102 offset:6272
    ds_read_b64_tr_b16 v[114:115], v102 offset:7808
    s_add_u32 m0, s49, 87040
    s_nop 0
    buffer_load_dwordx4 v97, s[4:7], s30 offen lds
    s_waitcnt lgkmcnt(10)
    v_mfma_f32_32x32x16_bf16 v[48:63], v[124:127], v[160:163], v[48:63]
    ds_read_b64_tr_b16 v[116:117], v103 offset:6336
    ds_read_b64_tr_b16 v[118:119], v103 offset:7872
    s_waitcnt lgkmcnt(10)
    v_mfma_f32_32x32x16_bf16 v[64:79], v[128:131], v[160:163], v[64:79]
    ds_read_b64_tr_b16 v[120:121], v102 offset:6400
    ds_read_b64_tr_b16 v[122:123], v102 offset:7936
    s_add_u32 m0, s50, 86016
    s_nop 0
    buffer_load_dwordx4 v99, s[8:11], s31 offen lds
    s_waitcnt lgkmcnt(10)
    v_mfma_f32_32x32x16_bf16 v[80:95], v[132:135], v[160:163], v[80:95]
    ds_read_b64_tr_b16 v[124:125], v103 offset:6464
    ds_read_b64_tr_b16 v[126:127], v103 offset:8000
    s_waitcnt lgkmcnt(10)
    v_mfma_f32_32x32x16_bf16 v[0:15], v[136:139], v[164:167], v[0:15]
    s_add_u32 m0, s50, 87040
    s_add_u32 s52, s31, 20480
    buffer_load_dwordx4 v99, s[8:11], s52 offen lds
    s_add_u32 s30, s30, 393216
    s_add_u32 s31, s31, 64
    s_waitcnt lgkmcnt(8)
    v_mfma_f32_32x32x16_bf16 v[16:31], v[140:143], v[164:167], v[16:31]
    s_waitcnt lgkmcnt(6)
    v_mfma_f32_32x32x16_bf16 v[32:47], v[112:115], v[164:167], v[32:47]
    s_waitcnt lgkmcnt(4)
    v_mfma_f32_32x32x16_bf16 v[48:63], v[116:119], v[164:167], v[48:63]
    s_waitcnt lgkmcnt(2)
    v_mfma_f32_32x32x16_bf16 v[64:79], v[120:123], v[164:167], v[64:79]
    s_waitcnt lgkmcnt(0)
    v_mfma_f32_32x32x16_bf16 v[80:95], v[124:127], v[164:167], v[80:95]
    s_waitcnt vmcnt(8)
    s_barrier
    v_add_u32 v102, 28672, v100
    v_add_u32 v106, 28672, v104
    v_add_u32 v103, 28672, v101
    v_add_u32 v107, 28672, v105
    ds_read_b128 v[160:163], v106
    ds_read_b128 v[164:167], v107
    ds_read_b64_tr_b16 v[112:113], v102 offset:0
    ds_read_b64_tr_b16 v[114:115], v102 offset:1536
    ds_read_b64_tr_b16 v[116:117], v103 offset:64
    ds_read_b64_tr_b16 v[118:119], v103 offset:1600
    ds_read_b64_tr_b16 v[120:121], v102 offset:128
    ds_read_b64_tr_b16 v[122:123], v102 offset:1664
    ds_read_b64_tr_b16 v[124:125], v103 offset:192
    ds_read_b64_tr_b16 v[126:127], v103 offset:1728
    ds_read_b64_tr_b16 v[128:129], v102 offset:256
    ds_read_b64_tr_b16 v[130:131], v102 offset:1792
    ds_read_b64_tr_b16 v[132:133], v103 offset:320
    ds_read_b64_tr_b16 v[134:135], v103 offset:1856
    s_waitcnt lgkmcnt(10)
    v_mfma_f32_32x32x16_bf16 v[0:15], v[112:115], v[160:163], v[0:15]
    ds_read_b64_tr_b16 v[136:137], v102 offset:6144
    ds_read_b64_tr_b16 v[138:139], v102 offset:7680
    s_waitcnt lgkmcnt(10)
    v_mfma_f32_32x32x16_bf16 v[16:31], v[116:119], v[160:163], v[16:31]
    ds_read_b64_tr_b16 v[140:141], v103 offset:6208
    ds_read_b64_tr_b16 v[142:143], v103 offset:7744
    s_waitcnt lgkmcnt(10)
    v_mfma_f32_32x32x16_bf16 v[32:47], v[120:123], v[160:163], v[32:47]
    ds_read_b64_tr_b16 v[112:113], v102 offset:6272
    ds_read_b64_tr_b16 v[114:115], v102 offset:7808
    s_waitcnt lgkmcnt(10)
    v_mfma_f32_32x32x16_bf16 v[48:63], v[124:127], v[160:163], v[48:63]
    ds_read_b64_tr_b16 v[116:117], v103 offset:6336
    ds_read_b64_tr_b16 v[118:119], v103 offset:7872
    s_waitcnt lgkmcnt(10)
    v_mfma_f32_32x32x16_bf16 v[64:79], v[128:131], v[160:163], v[64:79]
    ds_read_b64_tr_b16 v[120:121], v102 offset:6400
    ds_read_b64_tr_b16 v[122:123], v102 offset:7936
    s_waitcnt lgkmcnt(10)
    v_mfma_f32_32x32x16_bf16 v[80:95], v[132:135], v[160:163], v[80:95]
    ds_read_b64_tr_b16 v[124:125], v103 offset:6464
    ds_read_b64_tr_b16 v[126:127], v103 offset:8000
    s_waitcnt lgkmcnt(10)
    v_mfma_f32_32x32x16_bf16 v[0:15], v[136:139], v[164:167], v[0:15]
    s_waitcnt lgkmcnt(8)
    v_mfma_f32_32x32x16_bf16 v[16:31], v[140:143], v[164:167], v[16:31]
    s_waitcnt lgkmcnt(6)
    v_mfma_f32_32x32x16_bf16 v[32:47], v[112:115], v[164:167], v[32:47]
    s_waitcnt lgkmcnt(4)
    v_mfma_f32_32x32x16_bf16 v[48:63], v[116:119], v[164:167], v[48:63]
    s_waitcnt lgkmcnt(2)
    v_mfma_f32_32x32x16_bf16 v[64:79], v[120:123], v[164:167], v[64:79]
    s_waitcnt lgkmcnt(0)
    v_mfma_f32_32x32x16_bf16 v[80:95], v[124:127], v[164:167], v[80:95]
    s_waitcnt vmcnt(4)
    s_barrier
    v_add_u32 v102, 57344, v100
    v_add_u32 v106, 57344, v104
    v_add_u32 v103, 57344, v101
    v_add_u32 v107, 57344, v105
    ds_read_b128 v[160:163], v106
    ds_read_b128 v[164:167], v107
    ds_read_b64_tr_b16 v[112:113], v102 offset:0
    ds_read_b64_tr_b16 v[114:115], v102 offset:1536
    ds_read_b64_tr_b16 v[116:117], v103 offset:64
    ds_read_b64_tr_b16 v[118:119], v103 offset:1600
    ds_read_b64_tr_b16 v[120:121], v102 offset:128
    ds_read_b64_tr_b16 v[122:123], v102 offset:1664
    ds_read_b64_tr_b16 v[124:125], v103 offset:192
    ds_read_b64_tr_b16 v[126:127], v103 offset:1728
    ds_read_b64_tr_b16 v[128:129], v102 offset:256
    ds_read_b64_tr_b16 v[130:131], v102 offset:1792
    ds_read_b64_tr_b16 v[132:133], v103 offset:320
    ds_read_b64_tr_b16 v[134:135], v103 offset:1856
    s_waitcnt lgkmcnt(10)
    v_mfma_f32_32x32x16_bf16 v[0:15], v[112:115], v[160:163], v[0:15]
    ds_read_b64_tr_b16 v[136:137], v102 offset:6144
    ds_read_b64_tr_b16 v[138:139], v102 offset:7680
    s_add_u32 s52, s27, s49
    s_add_u32 m0, s52, 0
    s_nop 0
    buffer_load_dwordx4 v219, s[16:19], s48 offen nt lds
    s_waitcnt lgkmcnt(10)
    v_mfma_f32_32x32x16_bf16 v[16:31], v[116:119], v[160:163], v[16:31]
    ds_read_b64_tr_b16 v[140:141], v103 offset:6208
    ds_read_b64_tr_b16 v[142:143], v103 offset:7744
    s_waitcnt lgkmcnt(10)
    v_mfma_f32_32x32x16_bf16 v[32:47], v[120:123], v[160:163], v[32:47]
    ds_read_b64_tr_b16 v[112:113], v102 offset:6272
    ds_read_b64_tr_b16 v[114:115], v102 offset:7808
    s_add_u32 m0, s52, 1024
    s_nop 0
    buffer_load_dwordx4 v220, s[16:19], s48 offen nt lds
    s_waitcnt lgkmcnt(10)
    v_mfma_f32_32x32x16_bf16 v[48:63], v[124:127], v[160:163], v[48:63]
    ds_read_b64_tr_b16 v[116:117], v103 offset:6336
    ds_read_b64_tr_b16 v[118:119], v103 offset:7872
    s_waitcnt lgkmcnt(10)
    v_mfma_f32_32x32x16_bf16 v[64:79], v[128:131], v[160:163], v[64:79]
    ds_read_b64_tr_b16 v[120:121], v102 offset:6400
    ds_read_b64_tr_b16 v[122:123], v102 offset:7936
    s_add_u32 m0, s52, 2048
    s_nop 0
    buffer_load_dwordx4 v221, s[16:19], s48 offen nt lds
    s_waitcnt lgkmcnt(10)
    v_mfma_f32_32x32x16_bf16 v[80:95], v[132:135], v[160:163], v[80:95]
    ds_read_b64_tr_b16 v[124:125], v103 offset:6464
    ds_read_b64_tr_b16 v[126:127], v103 offset:8000
    s_waitcnt lgkmcnt(10)
    v_mfma_f32_32x32x16_bf16 v[0:15], v[136:139], v[164:167], v[0:15]
    s_add_u32 s52, s27, s49
    s_add_u32 s52, s52, 12288
    s_add_u32 s53, s48, 12288
    s_add_u32 m0, s52, 0
    s_nop 0
    buffer_load_dwordx4 v219, s[16:19], s53 offen nt lds
    s_waitcnt lgkmcnt(8)
    v_mfma_f32_32x32x16_bf16 v[16:31], v[140:143], v[164:167], v[16:31]
    s_waitcnt lgkmcnt(6)
    v_mfma_f32_32x32x16_bf16 v[32:47], v[112:115], v[164:167], v[32:47]
    s_add_u32 m0, s52, 1024
    s_nop 0
    buffer_load_dwordx4 v220, s[16:19], s53 offen nt lds
    s_waitcnt lgkmcnt(4)
    v_mfma_f32_32x32x16_bf16 v[48:63], v[116:119], v[164:167], v[48:63]
    s_waitcnt lgkmcnt(2)
    v_mfma_f32_32x32x16_bf16 v[64:79], v[120:123], v[164:167], v[64:79]
    s_add_u32 m0, s52, 2048
    s_nop 0
    buffer_load_dwordx4 v221, s[16:19], s53 offen nt lds
    s_add_u32 s48, s48, 24576
    s_waitcnt lgkmcnt(0)
    v_mfma_f32_32x32x16_bf16 v[80:95], v[124:127], v[164:167], v[80:95]
    s_waitcnt vmcnt(6)
    s_barrier
    v_add_u32 v102, 86016, v100
    v_add_u32 v106, 86016, v104
    v_add_u32 v103, 86016, v101
    v_add_u32 v107, 86016, v105
    ds_read_b128 v[160:163], v106
    ds_read_b128 v[164:167], v107
    ds_read_b64_tr_b16 v[112:113], v102 offset:0
    ds_read_b64_tr_b16 v[114:115], v102 offset:1536
    ds_read_b64_tr_b16 v[116:117], v103 offset:64
    ds_read_b64_tr_b16 v[118:119], v103 offset:1600
    ds_read_b64_tr_b16 v[120:121], v102 offset:128
    ds_read_b64_tr_b16 v[122:123], v102 offset:1664
    ds_read_b64_tr_b16 v[124:125], v103 offset:192
    ds_read_b64_tr_b16 v[126:127], v103 offset:1728
    ds_read_b64_tr_b16 v[128:129], v102 offset:256
    ds_read_b64_tr_b16 v[130:131], v102 offset:1792
    ds_read_b64_tr_b16 v[132:133], v103 offset:320
    ds_read_b64_tr_b16 v[134:135], v103 offset:1856
    s_waitcnt lgkmcnt(10)
    v_mfma_f32_32x32x16_bf16 v[0:15], v[112:115], v[160:163], v[0:15]
    ds_read_b64_tr_b16 v[136:137], v102 offset:6144
    ds_read_b64_tr_b16 v[138:139], v102 offset:7680
    s_waitcnt lgkmcnt(10)
    v_mfma_f32_32x32x16_bf16 v[16:31], v[116:119], v[160:163], v[16:31]
    ds_read_b64_tr_b16 v[140:141], v103 offset:6208
    ds_read_b64_tr_b16 v[142:143], v103 offset:7744
    s_waitcnt lgkmcnt(10)
    v_mfma_f32_32x32x16_bf16 v[32:47], v[120:123], v[160:163], v[32:47]
    ds_read_b64_tr_b16 v[112:113], v102 offset:6272
    ds_read_b64_tr_b16 v[114:115], v102 offset:7808
    s_waitcnt lgkmcnt(10)
    v_mfma_f32_32x32x16_bf16 v[48:63], v[124:127], v[160:163], v[48:63]
    ds_read_b64_tr_b16 v[116:117], v103 offset:6336
    ds_read_b64_tr_b16 v[118:119], v103 offset:7872
    s_waitcnt lgkmcnt(10)
    v_mfma_f32_32x32x16_bf16 v[64:79], v[128:131], v[160:163], v[64:79]
    ds_read_b64_tr_b16 v[120:121], v102 offset:6400
    ds_read_b64_tr_b16 v[122:123], v102 offset:7936
    s_waitcnt lgkmcnt(10)
    v_mfma_f32_32x32x16_bf16 v[80:95], v[132:135], v[160:163], v[80:95]
    ds_read_b64_tr_b16 v[124:125], v103 offset:6464
    ds_read_b64_tr_b16 v[126:127], v103 offset:8000
    s_waitcnt lgkmcnt(10)
    v_mfma_f32_32x32x16_bf16 v[0:15], v[136:139], v[164:167], v[0:15]
    s_waitcnt lgkmcnt(8)
    v_mfma_f32_32x32x16_bf16 v[16:31], v[140:143], v[164:167], v[16:31]
    s_waitcnt lgkmcnt(6)
    v_mfma_f32_32x32x16_bf16 v[32:47], v[112:115], v[164:167], v[32:47]
    s_waitcnt lgkmcnt(4)
    v_mfma_f32_32x32x16_bf16 v[48:63], v[116:119], v[164:167], v[48:63]
    s_waitcnt lgkmcnt(2)
    v_mfma_f32_32x32x16_bf16 v[64:79], v[120:123], v[164:167], v[64:79]
    s_waitcnt lgkmcnt(0)
    v_mfma_f32_32x32x16_bf16 v[80:95], v[124:127], v[164:167], v[80:95]
    s_branch K1_QE
K1_QB:
    s_mov_b32 s29, 4
K1_QLOOPB:
    s_waitcnt vmcnt(6)
    s_barrier
    v_add_u32 v102, 0, v100
    v_add_u32 v106, 0, v104
    v_add_u32 v103, 0, v101
    v_add_u32 v107, 0, v105
    ds_read_b128 v[160:163], v106
    ds_read_b128 v[164:167], v107
    ds_read_b64_tr_b16 v[112:113], v102 offset:0
    ds_read_b64_tr_b16 v[114:115], v102 offset:1536
    ds_read_b64_tr_b16 v[116:117], v103 offset:64
    ds_read_b64_tr_b16 v[118:119], v103 offset:1600
    ds_read_b64_tr_b16 v[120:121], v102 offset:128
    ds_read_b64_tr_b16 v[122:123], v102 offset:1664
    ds_read_b64_tr_b16 v[124:125], v103 offset:192
    ds_read_b64_tr_b16 v[126:127], v103 offset:1728
    ds_read_b64_tr_b16 v[128:129], v102 offset:256
    ds_read_b64_tr_b16 v[130:131], v102 offset:1792
    ds_read_b64_tr_b16 v[132:133], v103 offset:320
    ds_read_b64_tr_b16 v[134:135], v103 offset:1856
    s_waitcnt lgkmcnt(10)
    v_mfma_f32_32x32x16_bf16 v[0:15], v[112:115], v[160:163], v[0:15]
    ds_read_b64_tr_b16 v[136:137], v102 offset:6144
    ds_read_b64_tr_b16 v[138:139], v102 offset:7680
    s_add_u32 m0, s49, 88064
    s_nop 0
    buffer_load_dwordx4 v98, s[4:7], s30 offen lds
    s_waitcnt lgkmcnt(10)
    v_mfma_f32_32x32x16_bf16 v[16:31], v[116:119], v[160:163], v[16:31]
    ds_read_b64_tr_b16 v[140:141], v103 offset:6208
    ds_read_b64_tr_b16 v[142:143], v103 offset:7744
    s_waitcnt lgkmcnt(10)
    v_mfma_f32_32x32x16_bf16 v[32:47], v[120:123], v[160:163], v[32:47]
    ds_read_b64_tr_b16 v[112:113], v102 offset:6272
    ds_read_b64_tr_b16 v[114:115], v102 offset:7808
    s_add_u32 m0, s50, 86016
    s_nop 0
    buffer_load_dwordx4 v99, s[8:11], s31 offen lds
    s_waitcnt lgkmcnt(10)
    v_mfma_f32_32x32x16_bf16 v[48:63], v[124:127], v[160:163], v[48:63]
    ds_read_b64_tr_b16 v[116:117], v103 offset:6336
    ds_read_b64_tr_b16 v[118:119], v103 offset:7872
    s_waitcnt lgkmcnt(10)
    v_mfma_f32_32x32x16_bf16 v[64:79], v[128:131], v[160:163], v[64:79]
    ds_read_b64_tr_b16 v[120:121], v102 offset:6400
    ds_read_b64_tr_b16 v[122:123], v102 offset:7936
    s_add_u32 m0, s50, 87040
    s_add_u32 s52, s31, 20480
    buffer_load_dwordx4 v99, s[8:11], s52 offen lds
    s_add_u32 s30, s30, 393216
    s_add_u32 s31, s31, 64
    s_waitcnt lgkmcnt(10)
    v_mfma_f32_32x32x16_bf16 v[80:95], v[132:135], v[160:163], v[80:95]
    ds_read_b64_tr_b16 v[124:125], v103 offset:6464
    ds_read_b64_tr_b16 v[126:127], v103 offset:8000
    s_waitcnt lgkmcnt(10)
    v_mfma_f32_32x32x16_bf16 v[0:15], v[136:139], v[164:167], v[0:15]
    s_waitcnt lgkmcnt(8)
    v_mfma_f32_32x32x16_bf16 v[16:31], v[140:143], v[164:167], v[16:31]
    s_waitcnt lgkmcnt(6)
    v_mfma_f32_32x32x16_bf16 v[32:47], v[112:115], v[164:167], v[32:47]
    s_waitcnt lgkmcnt(4)
    v_mfma_f32_32x32x16_bf16 v[48:63], v[116:119], v[164:167], v[48:63]
    s_waitcnt lgkmcnt(2)
    v_mfma_f32_32x32x16_bf16 v[64:79], v[120:123], v[164:167], v[64:79]
    s_waitcnt lgkmcnt(0)
    v_mfma_f32_32x32x16_bf16 v[80:95], v[124:127], v[164:167], v[80:95]
    s_waitcnt vmcnt(6)
    s_barrier
    v_add_u32 v102, 28672, v100
    v_add_u32 v106, 28672, v104
    v_add_u32 v103, 28672, v101
    v_add_u32 v107, 28672, v105
    ds_read_b128 v[160:163], v106
    ds_read_b128 v[164:167], v107
    ds_read_b64_tr_b16 v[112:113], v102 offset:0
    ds_read_b64_tr_b16 v[114:115], v102 offset:1536
    ds_read_b64_tr_b16 v[116:117], v103 offset:64
    ds_read_b64_tr_b16 v[118:119], v103 offset:1600
    ds_read_b64_tr_b16 v[120:121], v102 offset:128
    ds_read_b64_tr_b16 v[122:123], v102 offset:1664
    ds_read_b64_tr_b16 v[124:125], v103 offset:192
    ds_read_b64_tr_b16 v[126:127], v103 offset:1728
    ds_read_b64_tr_b16 v[128:129], v102 offset:256
    ds_read_b64_tr_b16 v[130:131], v102 offset:1792
    ds_read_b64_tr_b16 v[132:133], v103 offset:320
    ds_read_b64_tr_b16 v[134:135], v103 offset:1856
    s_waitcnt lgkmcnt(10)
    v_mfma_f32_32x32x16_bf16 v[0:15], v[112:115], v[160:163], v[0:15]
    ds_read_b64_tr_b16 v[136:137], v102 offset:6144
    ds_read_b64_tr_b16 v[138:139], v102 offset:7680
    s_add_u32 m0, s49, 2048
    s_nop 0
    buffer_load_dwordx4 v98, s[4:7], s30 offen lds
    s_waitcnt lgkmcnt(10)
    v_mfma_f32_32x32x16_bf16 v[16:31], v[116:119], v[160:163], v[16:31]
    ds_read_b64_tr_b16 v[140:141], v103 offset:6208
    ds_read_b64_tr_b16 v[142:143], v103 offset:7744
    s_waitcnt lgkmcnt(10)
    v_mfma_f32_32x32x16_bf16 v[32:47], v[120:123], v[160:163], v[32:47]
    ds_read_b64_tr_b16 v[112:113], v102 offset:6272
    ds_read_b64_tr_b16 v[114:115], v102 offset:7808
    s_add_u32 m0, s50, 0
    s_nop 0
    buffer_load_dwordx4 v99, s[8:11], s31 offen lds
    s_waitcnt lgkmcnt(10)
    v_mfma_f32_32x32x16_bf16 v[48:63], v[124:127], v[160:163], v[48:63]
    ds_read_b64_tr_b16 v[116:117], v103 offset:6336
    ds_read_b64_tr_b16 v[118:119], v103 offset:7872
    s_waitcnt lgkmcnt(10)
    v_mfma_f32_32x32x16_bf16 v[64:79], v[128:131], v[160:163], v[64:79]
    ds_read_b64_tr_b16 v[120:121], v102 offset:6400
    ds_read_b64_tr_b16 v[122:123], v102 offset:7936
    s_add_u32 m0, s50, 1024
    s_add_u32 s52, s31, 20480
    buffer_load_dwordx4 v99, s[8:11], s52 offen lds
    s_add_u32 s30, s30, 393216
    s_add_u32 s31, s31, 64
    s_waitcnt lgkmcnt(10)
    v_mfma_f32_32x32x16_bf16 v[80:95], v[132:135], v[160:163], v[80:95]
    ds_read_b64_tr_b16 v[124:125], v103 offset:6464
    ds_read_b64_tr_b16 v[126:127], v103 offset:8000
    s_waitcnt lgkmcnt(10)
    v_mfma_f32_32x32x16_bf16 v[0:15], v[136:139], v[164:167], v[0:15]
    s_waitcnt lgkmcnt(8)
    v_mfma_f32_32x32x16_bf16 v[16:31], v[140:143], v[164:167], v[16:31]
    s_waitcnt lgkmcnt(6)
    v_mfma_f32_32x32x16_bf16 v[32:47], v[112:115], v[164:167], v[32:47]
    s_waitcnt lgkmcnt(4)
    v_mfma_f32_32x32x16_bf16 v[48:63], v[116:119], v[164:167], v[48:63]
    s_waitcnt lgkmcnt(2)
    v_mfma_f32_32x32x16_bf16 v[64:79], v[120:123], v[164:167], v[64:79]
    s_waitcnt lgkmcnt(0)
    v_mfma_f32_32x32x16_bf16 v[80:95], v[124:127], v[164:167], v[80:95]
    s_waitcnt vmcnt(6)
    s_barrier
    v_add_u32 v102, 57344, v100
    v_add_u32 v106, 57344, v104
    v_add_u32 v103, 57344, v101
    v_add_u32 v107, 57344, v105
    ds_read_b128 v[160:163], v106
    ds_read_b128 v[164:167], v107
    ds_read_b64_tr_b16 v[112:113], v102 offset:0
    ds_read_b64_tr_b16 v[114:115], v102 offset:1536
    ds_read_b64_tr_b16 v[116:117], v103 offset:64
    ds_read_b64_tr_b16 v[118:119], v103 offset:1600
    ds_read_b64_tr_b16 v[120:121], v102 offset:128
    ds_read_b64_tr_b16 v[122:123], v102 offset:1664
    ds_read_b64_tr_b16 v[124:125], v103 offset:192
    ds_read_b64_tr_b16 v[126:127], v103 offset:1728
    ds_read_b64_tr_b16 v[128:129], v102 offset:256
    ds_read_b64_tr_b16 v[130:131], v102 offset:1792
    ds_read_b64_tr_b16 v[132:133], v103 offset:320
    ds_read_b64_tr_b16 v[134:135], v103 offset:1856
    s_waitcnt lgkmcnt(10)
    v_mfma_f32_32x32x16_bf16 v[0:15], v[112:115], v[160:163], v[0:15]
    ds_read_b64_tr_b16 v[136:137], v102 offset:6144
    ds_read_b64_tr_b16 v[138:139], v102 offset:7680
    s_add_u32 m0, s49, 30720
    s_nop 0
    buffer_load_dwordx4 v98, s[4:7], s30 offen lds
    s_waitcnt lgkmcnt(10)
    v_mfma_f32_32x32x16_bf16 v[16:31], v[116:119], v[160:163], v[16:31]
    ds_read_b64_tr_b16 v[140:141], v103 offset:6208
    ds_read_b64_tr_b16 v[142:143], v103 offset:7744
    s_waitcnt lgkmcnt(10)
    v_mfma_f32_32x32x16_bf16 v[32:47], v[120:123], v[160:163], v[32:47]
    ds_read_b64_tr_b16 v[112:113], v102 offset:6272
    ds_read_b64_tr_b16 v[114:115], v102 offset:7808
    s_add_u32 m0, s50, 28672
    s_nop 0
    buffer_load_dwordx4 v99, s[8:11], s31 offen lds
    s_waitcnt lgkmcnt(10)
    v_mfma_f32_32x32x16_bf16 v[48:63], v[124:127], v[160:163], v[48:63]
    ds_read_b64_tr_b16 v[116:117], v103 offset:6336
    ds_read_b64_tr_b16 v[118:119], v103 offset:7872
    s_waitcnt lgkmcnt(10)
    v_mfma_f32_32x32x16_bf16 v[64:79], v[128:131], v[160:163], v[64:79]
    ds_read_b64_tr_b16 v[120:121], v102 offset:6400
    ds_read_b64_tr_b16 v[122:123], v102 offset:7936
    s_add_u32 m0, s50, 29696
    s_add_u32 s52, s31, 20480
    buffer_load_dwordx4 v99, s[8:11], s52 offen lds
    s_add_u32 s30, s30, 393216
    s_add_u32 s31, s31, 64
    s_waitcnt lgkmcnt(10)
    v_mfma_f32_32x32x16_bf16 v[80:95], v[132:135], v[160:163], v[80:95]
    ds_read_b64_tr_b16 v[124:125], v103 offset:6464
    ds_read_b64_tr_b16 v[126:127], v103 offset:8000
    s_waitcnt lgkmcnt(10)
    v_mfma_f32_32x32x16_bf16 v[0:15], v[136:139], v[164:167], v[0:15]
    s_waitcnt lgkmcnt(8)
    v_mfma_f32_32x32x16_bf16 v[16:31], v[140:143], v[164:167], v[16:31]
    s_waitcnt lgkmcnt(6)
    v_mfma_f32_32x32x16_bf16 v[32:47], v[112:115], v[164:167], v[32:47]
    s_waitcnt lgkmcnt(4)
    v_mfma_f32_32x32x16_bf16 v[48:63], v[116:119], v[164:167], v[48:63]
    s_waitcnt lgkmcnt(2)
    v_mfma_f32_32x32x16_bf16 v[64:79], v[120:123], v[164:167], v[64:79]
    s_waitcnt lgkmcnt(0)
    v_mfma_f32_32x32x16_bf16 v[80:95], v[124:127], v[164:167], v[80:95]
    s_waitcnt vmcnt(6)
    s_barrier
    v_add_u32 v102, 86016, v100
    v_add_u32 v106, 86016, v104
    v_add_u32 v103, 86016, v101
    v_add_u32 v107, 86016, v105
    ds_read_b128 v[160:163], v106
    ds_read_b128 v[164:167], v107
    ds_read_b64_tr_b16 v[112:113], v102 offset:0
    ds_read_b64_tr_b16 v[114:115], v102 offset:1536
    ds_read_b64_tr_b16 v[116:117], v103 offset:64
    ds_read_b64_tr_b16 v[118:119], v103 offset:1600
    ds_read_b64_tr_b16 v[120:121], v102 offset:128
    ds_read_b64_tr_b16 v[122:123], v102 offset:1664
    ds_read_b64_tr_b16 v[124:125], v103 offset:192
    ds_read_b64_tr_b16 v[126:127], v103 offset:1728
    ds_read_b64_tr_b16 v[128:129], v102 offset:256
    ds_read_b64_tr_b16 v[130:131], v102 offset:1792
    ds_read_b64_tr_b16 v[132:133], v103 offset:320
    ds_read_b64_tr_b16 v[134:135], v103 offset:1856
    s_waitcnt lgkmcnt(10)
    v_mfma_f32_32x32x16_bf16 v[0:15], v[112:115], v[160:163], v[0:15]
    ds_read_b64_tr_b16 v[136:137], v102 offset:6144
    ds_read_b64_tr_b16 v[138:139], v102 offset:7680
    s_add_u32 m0, s49, 59392
    s_nop 0
    buffer_load_dwordx4 v98, s[4:7], s30 offen lds
    s_waitcnt lgkmcnt(10)
    v_mfma_f32_32x32x16_bf16 v[16:31], v[116:119], v[160:163], v[16:31]
    ds_read_b64_tr_b16 v[140:141], v103 offset:6208
    ds_read_b64_tr_b16 v[142:143], v103 offset:7744
    s_waitcnt lgkmcnt(10)
    v_mfma_f32_32x32x16_bf16 v[32:47], v[120:123], v[160:163], v[32:47]
    ds_read_b64_tr_b16 v[112:113], v102 offset:6272
    ds_read_b64_tr_b16 v[114:115], v102 offset:7808
    s_add_u32 m0, s50, 57344
    s_nop 0
    buffer_load_dwordx4 v99, s[8:11], s31 offen lds
    s_waitcnt lgkmcnt(10)
    v_mfma_f32_32x32x16_bf16 v[48:63], v[124:127], v[160:163], v[48:63]
    ds_read_b64_tr_b16 v[116:117], v103 offset:6336
    ds_read_b64_tr_b16 v[118:119], v103 offset:7872
    s_waitcnt lgkmcnt(10)
    v_mfma_f32_32x32x16_bf16 v[64:79], v[128:131], v[160:163], v[64:79]
    ds_read_b64_tr_b16 v[120:121], v102 offset:6400
    ds_read_b64_tr_b16 v[122:123], v102 offset:7936
    s_add_u32 m0, s50, 58368
    s_add_u32 s52, s31, 20480
    buffer_load_dwordx4 v99, s[8:11], s52 offen lds
    s_add_u32 s30, s30, 393216
    s_add_u32 s31, s31, 64
    s_waitcnt lgkmcnt(10)
    v_mfma_f32_32x32x16_bf16 v[80:95], v[132:135], v[160:163], v[80:95]
    ds_read_b64_tr_b16 v[124:125], v103 offset:6464
    ds_read_b64_tr_b16 v[126:127], v103 offset:8000
    s_waitcnt lgkmcnt(10)
    v_mfma_f32_32x32x16_bf16 v[0:15], v[136:139], v[164:167], v[0:15]
    s_waitcnt lgkmcnt(8)
    v_mfma_f32_32x32x16_bf16 v[16:31], v[140:143], v[164:167], v[16:31]
    s_waitcnt lgkmcnt(6)
    v_mfma_f32_32x32x16_bf16 v[32:47], v[112:115], v[164:167], v[32:47]
    s_waitcnt lgkmcnt(4)
    v_mfma_f32_32x32x16_bf16 v[48:63], v[116:119], v[164:167], v[48:63]
    s_waitcnt lgkmcnt(2)
    v_mfma_f32_32x32x16_bf16 v[64:79], v[120:123], v[164:167], v[64:79]
    s_waitcnt lgkmcnt(0)
    v_mfma_f32_32x32x16_bf16 v[80:95], v[124:127], v[164:167], v[80:95]
    s_sub_u32 s29, s29, 1
    s_cmp_lg_u32 s29, 0
    s_cbranch_scc1 K1_QLOOPB
    s_waitcnt vmcnt(6)
    s_barrier
    v_add_u32 v102, 0, v100
    v_add_u32 v106, 0, v104
    v_add_u32 v103, 0, v101
    v_add_u32 v107, 0, v105
    ds_read_b128 v[160:163], v106
    ds_read_b128 v[164:167], v107
    ds_read_b64_tr_b16 v[112:113], v102 offset:0
    ds_read_b64_tr_b16 v[114:115], v102 offset:1536
    ds_read_b64_tr_b16 v[116:117], v103 offset:64
    ds_read_b64_tr_b16 v[118:119], v103 offset:1600
    ds_read_b64_tr_b16 v[120:121], v102 offset:128
    ds_read_b64_tr_b16 v[122:123], v102 offset:1664
    ds_read_b64_tr_b16 v[124:125], v103 offset:192
    ds_read_b64_tr_b16 v[126:127], v103 offset:1728
    ds_read_b64_tr_b16 v[128:129], v102 offset:256
    ds_read_b64_tr_b16 v[130:131], v102 offset:1792
    ds_read_b64_tr_b16 v[132:133], v103 offset:320
    ds_read_b64_tr_b16 v[134:135], v103 offset:1856
    s_waitcnt lgkmcnt(10)
    v_mfma_f32_32x32x16_bf16 v[0:15], v[112:115], v[160:163], v[0:15]
    ds_read_b64_tr_b16 v[136:137], v102 offset:6144
    ds_read_b64_tr_b16 v[138:139], v102 offset:7680
    s_add_u32 m0, s49, 88064
    s_nop 0
    buffer_load_dwordx4 v98, s[4:7], s30 offen lds
    s_waitcnt lgkmcnt(10)
    v_mfma_f32_32x32x16_bf16 v[16:31], v[116:119], v[160:163], v[16:31]
    ds_read_b64_tr_b16 v[140:141], v103 offset:6208
    ds_read_b64_tr_b16 v[142:143], v103 offset:7744
    s_waitcnt lgkmcnt(10)
    v_mfma_f32_32x32x16_bf16 v[32:47], v[120:123], v[160:163], v[32:47]
    ds_read_b64_tr_b16 v[112:113], v102 offset:6272
    ds_read_b64_tr_b16 v[114:115], v102 offset:7808
    s_add_u32 m0, s50, 86016
    s_nop 0
    buffer_load_dwordx4 v99, s[8:11], s31 offen lds
    s_waitcnt lgkmcnt(10)
    v_mfma_f32_32x32x16_bf16 v[48:63], v[124:127], v[160:163], v[48:63]
    ds_read_b64_tr_b16 v[116:117], v103 offset:6336
    ds_read_b64_tr_b16 v[118:119], v103 offset:7872
    s_waitcnt lgkmcnt(10)
    v_mfma_f32_32x32x16_bf16 v[64:79], v[128:131], v[160:163], v[64:79]
    ds_read_b64_tr_b16 v[120:121], v102 offset:6400
    ds_read_b64_tr_b16 v[122:123], v102 offset:7936
    s_add_u32 m0, s50, 87040
    s_add_u32 s52, s31, 20480
    buffer_load_dwordx4 v99, s[8:11], s52 offen lds
    s_add_u32 s30, s30, 393216
    s_add_u32 s31, s31, 64
    s_waitcnt lgkmcnt(10)
    v_mfma_f32_32x32x16_bf16 v[80:95], v[132:135], v[160:163], v[80:95]
    ds_read_b64_tr_b16 v[124:125], v103 offset:6464
    ds_read_b64_tr_b16 v[126:127], v103 offset:8000
    s_waitcnt lgkmcnt(10)
    v_mfma_f32_32x32x16_bf16 v[0:15], v[136:139], v[164:167], v[0:15]
    s_waitcnt lgkmcnt(8)
    v_mfma_f32_32x32x16_bf16 v[16:31], v[140:143], v[164:167], v[16:31]
    s_waitcnt lgkmcnt(6)
    v_mfma_f32_32x32x16_bf16 v[32:47], v[112:115], v[164:167], v[32:47]
    s_waitcnt lgkmcnt(4)
    v_mfma_f32_32x32x16_bf16 v[48:63], v[116:119], v[164:167], v[48:63]
    s_waitcnt lgkmcnt(2)
    v_mfma_f32_32x32x16_bf16 v[64:79], v[120:123], v[164:167], v[64:79]
    s_waitcnt lgkmcnt(0)
    v_mfma_f32_32x32x16_bf16 v[80:95], v[124:127], v[164:167], v[80:95]
    s_waitcnt vmcnt(6)
    s_barrier
    v_add_u32 v102, 28672, v100
    v_add_u32 v106, 28672, v104
    v_add_u32 v103, 28672, v101
    v_add_u32 v107, 28672, v105
    ds_read_b128 v[160:163], v106
    ds_read_b128 v[164:167], v107
    ds_read_b64_tr_b16 v[112:113], v102 offset:0
    ds_read_b64_tr_b16 v[114:115], v102 offset:1536
    ds_read_b64_tr_b16 v[116:117], v103 offset:64
    ds_read_b64_tr_b16 v[118:119], v103 offset:1600
    ds_read_b64_tr_b16 v[120:121], v102 offset:128
    ds_read_b64_tr_b16 v[122:123], v102 offset:1664
    ds_read_b64_tr_b16 v[124:125], v103 offset:192
    ds_read_b64_tr_b16 v[126:127], v103 offset:1728
    ds_read_b64_tr_b16 v[128:129], v102 offset:256
    ds_read_b64_tr_b16 v[130:131], v102 offset:1792
    ds_read_b64_tr_b16 v[132:133], v103 offset:320
    ds_read_b64_tr_b16 v[134:135], v103 offset:1856
    s_waitcnt lgkmcnt(10)
    v_mfma_f32_32x32x16_bf16 v[0:15], v[112:115], v[160:163], v[0:15]
    ds_read_b64_tr_b16 v[136:137], v102 offset:6144
    ds_read_b64_tr_b16 v[138:139], v102 offset:7680
    s_waitcnt lgkmcnt(10)
    v_mfma_f32_32x32x16_bf16 v[16:31], v[116:119], v[160:163], v[16:31]
    ds_read_b64_tr_b16 v[140:141], v103 offset:6208
    ds_read_b64_tr_b16 v[142:143], v103 offset:7744
    s_waitcnt lgkmcnt(10)
    v_mfma_f32_32x32x16_bf16 v[32:47], v[120:123], v[160:163], v[32:47]
    ds_read_b64_tr_b16 v[112:113], v102 offset:6272
    ds_read_b64_tr_b16 v[114:115], v102 offset:7808
    s_waitcnt lgkmcnt(10)
    v_mfma_f32_32x32x16_bf16 v[48:63], v[124:127], v[160:163], v[48:63]
    ds_read_b64_tr_b16 v[116:117], v103 offset:6336
    ds_read_b64_tr_b16 v[118:119], v103 offset:7872
    s_waitcnt lgkmcnt(10)
    v_mfma_f32_32x32x16_bf16 v[64:79], v[128:131], v[160:163], v[64:79]
    ds_read_b64_tr_b16 v[120:121], v102 offset:6400
    ds_read_b64_tr_b16 v[122:123], v102 offset:7936
    s_waitcnt lgkmcnt(10)
    v_mfma_f32_32x32x16_bf16 v[80:95], v[132:135], v[160:163], v[80:95]
    ds_read_b64_tr_b16 v[124:125], v103 offset:6464
    ds_read_b64_tr_b16 v[126:127], v103 offset:8000
    s_waitcnt lgkmcnt(10)
    v_mfma_f32_32x32x16_bf16 v[0:15], v[136:139], v[164:167], v[0:15]
    s_waitcnt lgkmcnt(8)
    v_mfma_f32_32x32x16_bf16 v[16:31], v[140:143], v[164:167], v[16:31]
    s_waitcnt lgkmcnt(6)
    v_mfma_f32_32x32x16_bf16 v[32:47], v[112:115], v[164:167], v[32:47]
    s_waitcnt lgkmcnt(4)
    v_mfma_f32_32x32x16_bf16 v[48:63], v[116:119], v[164:167], v[48:63]
    s_waitcnt lgkmcnt(2)
    v_mfma_f32_32x32x16_bf16 v[64:79], v[120:123], v[164:167], v[64:79]
    s_waitcnt lgkmcnt(0)
    v_mfma_f32_32x32x16_bf16 v[80:95], v[124:127], v[164:167], v[80:95]
    s_waitcnt vmcnt(3)
    s_barrier
    v_add_u32 v102, 57344, v100
    v_add_u32 v106, 57344, v104
    v_add_u32 v103, 57344, v101
    v_add_u32 v107, 57344, v105
    ds_read_b128 v[160:163], v106
    ds_read_b128 v[164:167], v107
    ds_read_b64_tr_b16 v[112:113], v102 offset:0
    ds_read_b64_tr_b16 v[114:115], v102 offset:1536
    ds_read_b64_tr_b16 v[116:117], v103 offset:64
    ds_read_b64_tr_b16 v[118:119], v103 offset:1600
    ds_read_b64_tr_b16 v[120:121], v102 offset:128
    ds_read_b64_tr_b16 v[122:123], v102 offset:1664
    ds_read_b64_tr_b16 v[124:125], v103 offset:192
    ds_read_b64_tr_b16 v[126:127], v103 offset:1728
    ds_read_b64_tr_b16 v[128:129], v102 offset:256
    ds_read_b64_tr_b16 v[130:131], v102 offset:1792
    ds_read_b64_tr_b16 v[132:133], v103 offset:320
    ds_read_b64_tr_b16 v[134:135], v103 offset:1856
    s_waitcnt lgkmcnt(10)
    v_mfma_f32_32x32x16_bf16 v[0:15], v[112:115], v[160:163], v[0:15]
    ds_read_b64_tr_b16 v[136:137], v102 offset:6144
    ds_read_b64_tr_b16 v[138:139], v102 offset:7680
    s_add_u32 s52, s27, s49
    s_add_u32 m0, s52, 0
    s_nop 0
    buffer_load_dwordx4 v219, s[16:19], s48 offen nt lds
    s_waitcnt lgkmcnt(10)
    v_mfma_f32_32x32x16_bf16 v[16:31], v[116:119], v[160:163], v[16:31]
    ds_read_b64_tr_b16 v[140:141], v103 offset:6208
    ds_read_b64_tr_b16 v[142:143], v103 offset:7744
    s_waitcnt lgkmcnt(10)
    v_mfma_f32_32x32x16_bf16 v[32:47], v[120:123], v[160:163], v[32:47]
    ds_read_b64_tr_b16 v[112:113], v102 offset:6272
    ds_read_b64_tr_b16 v[114:115], v102 offset:7808
    s_add_u32 m0, s52, 1024
    s_nop 0
    buffer_load_dwordx4 v220, s[16:19], s48 offen nt lds
    s_waitcnt lgkmcnt(10)
    v_mfma_f32_32x32x16_bf16 v[48:63], v[124:127], v[160:163], v[48:63]
    ds_read_b64_tr_b16 v[116:117], v103 offset:6336
    ds_read_b64_tr_b16 v[118:119], v103 offset:7872
    s_waitcnt lgkmcnt(10)
    v_mfma_f32_32x32x16_bf16 v[64:79], v[128:131], v[160:163], v[64:79]
    ds_read_b64_tr_b16 v[120:121], v102 offset:6400
    ds_read_b64_tr_b16 v[122:123], v102 offset:7936
    s_add_u32 m0, s52, 2048
    s_nop 0
    buffer_load_dwordx4 v221, s[16:19], s48 offen nt lds
    s_waitcnt lgkmcnt(10)
    v_mfma_f32_32x32x16_bf16 v[80:95], v[132:135], v[160:163], v[80:95]
    ds_read_b64_tr_b16 v[124:125], v103 offset:6464
    ds_read_b64_tr_b16 v[126:127], v103 offset:8000
    s_waitcnt lgkmcnt(10)
    v_mfma_f32_32x32x16_bf16 v[0:15], v[136:139], v[164:167], v[0:15]
    s_add_u32 s52, s27, s49
    s_add_u32 s52, s52, 12288
    s_add_u32 s53, s48, 12288
    s_add_u32 m0, s52, 0
    s_nop 0
    buffer_load_dwordx4 v219, s[16:19], s53 offen nt lds
    s_waitcnt lgkmcnt(8)
    v_mfma_f32_32x32x16_bf16 v[16:31], v[140:143], v[164:167], v[16:31]
    s_waitcnt lgkmcnt(6)
    v_mfma_f32_32x32x16_bf16 v[32:47], v[112:115], v[164:167], v[32:47]
    s_add_u32 m0, s52, 1024
    s_nop 0
    buffer_load_dwordx4 v220, s[16:19], s53 offen nt lds
    s_waitcnt lgkmcnt(4)
    v_mfma_f32_32x32x16_bf16 v[48:63], v[116:119], v[164:167], v[48:63]
    s_waitcnt lgkmcnt(2)
    v_mfma_f32_32x32x16_bf16 v[64:79], v[120:123], v[164:167], v[64:79]
    s_add_u32 m0, s52, 2048
    s_nop 0
    buffer_load_dwordx4 v221, s[16:19], s53 offen nt lds
    s_add_u32 s48, s48, 24576
    s_waitcnt lgkmcnt(0)
    v_mfma_f32_32x32x16_bf16 v[80:95], v[124:127], v[164:167], v[80:95]
    s_waitcnt vmcnt(6)
    s_barrier
    v_add_u32 v102, 86016, v100
    v_add_u32 v106, 86016, v104
    v_add_u32 v103, 86016, v101
    v_add_u32 v107, 86016, v105
    ds_read_b128 v[160:163], v106
    ds_read_b128 v[164:167], v107
    ds_read_b64_tr_b16 v[112:113], v102 offset:0
    ds_read_b64_tr_b16 v[114:115], v102 offset:1536
    ds_read_b64_tr_b16 v[116:117], v103 offset:64
    ds_read_b64_tr_b16 v[118:119], v103 offset:1600
    ds_read_b64_tr_b16 v[120:121], v102 offset:128
    ds_read_b64_tr_b16 v[122:123], v102 offset:1664
    ds_read_b64_tr_b16 v[124:125], v103 offset:192
    ds_read_b64_tr_b16 v[126:127], v103 offset:1728
    ds_read_b64_tr_b16 v[128:129], v102 offset:256
    ds_read_b64_tr_b16 v[130:131], v102 offset:1792
    ds_read_b64_tr_b16 v[132:133], v103 offset:320
    ds_read_b64_tr_b16 v[134:135], v103 offset:1856
    s_waitcnt lgkmcnt(10)
    v_mfma_f32_32x32x16_bf16 v[0:15], v[112:115], v[160:163], v[0:15]
    ds_read_b64_tr_b16 v[136:137], v102 offset:6144
    ds_read_b64_tr_b16 v[138:139], v102 offset:7680
    s_waitcnt lgkmcnt(10)
    v_mfma_f32_32x32x16_bf16 v[16:31], v[116:119], v[160:163], v[16:31]
    ds_read_b64_tr_b16 v[140:141], v103 offset:6208
    ds_read_b64_tr_b16 v[142:143], v103 offset:7744
    s_waitcnt lgkmcnt(10)
    v_mfma_f32_32x32x16_bf16 v[32:47], v[120:123], v[160:163], v[32:47]
    ds_read_b64_tr_b16 v[112:113], v102 offset:6272
    ds_read_b64_tr_b16 v[114:115], v102 offset:7808
    s_waitcnt lgkmcnt(10)
    v_mfma_f32_32x32x16_bf16 v[48:63], v[124:127], v[160:163], v[48:63]
    ds_read_b64_tr_b16 v[116:117], v103 offset:6336
    ds_read_b64_tr_b16 v[118:119], v103 offset:7872
    s_waitcnt lgkmcnt(10)
    v_mfma_f32_32x32x16_bf16 v[64:79], v[128:131], v[160:163], v[64:79]
    ds_read_b64_tr_b16 v[120:121], v102 offset:6400
    ds_read_b64_tr_b16 v[122:123], v102 offset:7936
    s_waitcnt lgkmcnt(10)
    v_mfma_f32_32x32x16_bf16 v[80:95], v[132:135], v[160:163], v[80:95]
    ds_read_b64_tr_b16 v[124:125], v103 offset:6464
    ds_read_b64_tr_b16 v[126:127], v103 offset:8000
    s_waitcnt lgkmcnt(10)
    v_mfma_f32_32x32x16_bf16 v[0:15], v[136:139], v[164:167], v[0:15]
    s_waitcnt lgkmcnt(8)
    v_mfma_f32_32x32x16_bf16 v[16:31], v[140:143], v[164:167], v[16:31]
    s_waitcnt lgkmcnt(6)
    v_mfma_f32_32x32x16_bf16 v[32:47], v[112:115], v[164:167], v[32:47]
    s_waitcnt lgkmcnt(4)
    v_mfma_f32_32x32x16_bf16 v[48:63], v[116:119], v[164:167], v[48:63]
    s_waitcnt lgkmcnt(2)
    v_mfma_f32_32x32x16_bf16 v[64:79], v[120:123], v[164:167], v[64:79]
    s_waitcnt lgkmcnt(0)
    v_mfma_f32_32x32x16_bf16 v[80:95], v[124:127], v[164:167], v[80:95]
    s_branch K1_QE
K1_QE:
    s_nop 7
    s_nop 3
    v_cvt_pk_bf16_f32 v128, v0, v1
    v_cvt_pk_bf16_f32 v129, v2, v3
    v_cvt_pk_bf16_f32 v130, v4, v5
    v_cvt_pk_bf16_f32 v131, v6, v7
    v_cvt_pk_bf16_f32 v132, v8, v9
    v_cvt_pk_bf16_f32 v133, v10, v11
    v_cvt_pk_bf16_f32 v134, v12, v13
    v_cvt_pk_bf16_f32 v135, v14, v15
    v_cvt_pk_bf16_f32 v136, v16, v17
    v_cvt_pk_bf16_f32 v137, v18, v19
    v_cvt_pk_bf16_f32 v138, v20, v21
    v_cvt_pk_bf16_f32 v139, v22, v23
    v_cvt_pk_bf16_f32 v140, v24, v25
    v_cvt_pk_bf16_f32 v141, v26, v27
    v_cvt_pk_bf16_f32 v142, v28, v29
    v_cvt_pk_bf16_f32 v143, v30, v31
    v_cvt_pk_bf16_f32 v144, v32, v33
    v_cvt_pk_bf16_f32 v145, v34, v35
    v_cvt_pk_bf16_f32 v146, v36, v37
    v_cvt_pk_bf16_f32 v147, v38, v39
    v_cvt_pk_bf16_f32 v148, v40, v41
    v_cvt_pk_bf16_f32 v149, v42, v43
    v_cvt_pk_bf16_f32 v150, v44, v45
    v_cvt_pk_bf16_f32 v151, v46, v47
    v_cvt_pk_bf16_f32 v152, v48, v49
    v_cvt_pk_bf16_f32 v153, v50, v51
    v_cvt_pk_bf16_f32 v154, v52, v53
    v_cvt_pk_bf16_f32 v155, v54, v55
    v_cvt_pk_bf16_f32 v156, v56, v57
    v_cvt_pk_bf16_f32 v157, v58, v59
    v_cvt_pk_bf16_f32 v158, v60, v61
    v_cvt_pk_bf16_f32 v159, v62, v63
    v_cvt_pk_bf16_f32 v160, v64, v65
    v_cvt_pk_bf16_f32 v161, v66, v67
    v_cvt_pk_bf16_f32 v162, v68, v69
    v_cvt_pk_bf16_f32 v163, v70, v71
    v_cvt_pk_bf16_f32 v164, v72, v73
    v_cvt_pk_bf16_f32 v165, v74, v75
    v_cvt_pk_bf16_f32 v166, v76, v77
    v_cvt_pk_bf16_f32 v167, v78, v79
    v_cvt_pk_bf16_f32 v168, v80, v81
    v_cvt_pk_bf16_f32 v169, v82, v83
    v_cvt_pk_bf16_f32 v170, v84, v85
    v_cvt_pk_bf16_f32 v171, v86, v87
    v_cvt_pk_bf16_f32 v172, v88, v89
    v_cvt_pk_bf16_f32 v173, v90, v91
    v_cvt_pk_bf16_f32 v174, v92, v93
    v_cvt_pk_bf16_f32 v175, v94, v95
    v_mov_b32 v0, 0
    v_mov_b32 v1, 0
    v_mov_b32 v2, 0
    v_mov_b32 v3, 0
    v_mov_b32 v4, 0
    v_mov_b32 v5, 0
    v_mov_b32 v6, 0
    v_mov_b32 v7, 0
    v_mov_b32 v8, 0
    v_mov_b32 v9, 0
    v_mov_b32 v10, 0
    v_mov_b32 v11, 0
    v_mov_b32 v12, 0
    v_mov_b32 v13, 0
    v_mov_b32 v14, 0
    v_mov_b32 v15, 0
    v_mov_b32 v16, 0
    v_mov_b32 v17, 0
    v_mov_b32 v18, 0
    v_mov_b32 v19, 0
    v_mov_b32 v20, 0
    v_mov_b32 v21, 0
    v_mov_b32 v22, 0
    v_mov_b32 v23, 0
    v_mov_b32 v24, 0
    v_mov_b32 v25, 0
    v_mov_b32 v26, 0
    v_mov_b32 v27, 0
    v_mov_b32 v28, 0
    v_mov_b32 v29, 0
    v_mov_b32 v30, 0
    v_mov_b32 v31, 0
    v_mov_b32 v32, 0
    v_mov_b32 v33, 0
    v_mov_b32 v34, 0
    v_mov_b32 v35, 0
    v_mov_b32 v36, 0
    v_mov_b32 v37, 0
    v_mov_b32 v38, 0
    v_mov_b32 v39, 0
    v_mov_b32 v40, 0
    v_mov_b32 v41, 0
    v_mov_b32 v42, 0
    v_mov_b32 v43, 0
    v_mov_b32 v44, 0
    v_mov_b32 v45, 0
    v_mov_b32 v46, 0
    v_mov_b32 v47, 0
    v_mov_b32 v48, 0
    v_mov_b32 v49, 0
    v_mov_b32 v50, 0
    v_mov_b32 v51, 0
    v_mov_b32 v52, 0
    v_mov_b32 v53, 0
    v_mov_b32 v54, 0
    v_mov_b32 v55, 0
    v_mov_b32 v56, 0
    v_mov_b32 v57, 0
    v_mov_b32 v58, 0
    v_mov_b32 v59, 0
    v_mov_b32 v60, 0
    v_mov_b32 v61, 0
    v_mov_b32 v62, 0
    v_mov_b32 v63, 0
    v_mov_b32 v64, 0
    v_mov_b32 v65, 0
    v_mov_b32 v66, 0
    v_mov_b32 v67, 0
    v_mov_b32 v68, 0
    v_mov_b32 v69, 0
    v_mov_b32 v70, 0
    v_mov_b32 v71, 0
    v_mov_b32 v72, 0
    v_mov_b32 v73, 0
    v_mov_b32 v74, 0
    v_mov_b32 v75, 0
    v_mov_b32 v76, 0
    v_mov_b32 v77, 0
    v_mov_b32 v78, 0
    v_mov_b32 v79, 0
    v_mov_b32 v80, 0
    v_mov_b32 v81, 0
    v_mov_b32 v82, 0
    v_mov_b32 v83, 0
    v_mov_b32 v84, 0
    v_mov_b32 v85, 0
    v_mov_b32 v86, 0
    v_mov_b32 v87, 0
    v_mov_b32 v88, 0
    v_mov_b32 v89, 0
    v_mov_b32 v90, 0
    v_mov_b32 v91, 0
    v_mov_b32 v92, 0
    v_mov_b32 v93, 0
    v_mov_b32 v94, 0
    v_mov_b32 v95, 0
    v_mov_b32 v234, 0xf149f2ca
    v_mov_b32 v235, 0
    v_mov_b32 v236, 0
    v_mov_b32 v237, 0
    v_mov_b32 v238, 0
    v_mov_b32 v239, 0
    s_mov_b32 s29, 7
K1_KVLOOP:
    s_waitcnt vmcnt(6)
    s_barrier
    v_add_u32 v226, s26, v222
    v_add_u32 v227, s26, v223
    v_add_u32 v228, s26, v224
    v_add_u32 v229, s26, v225
    ds_read_b128 v[192:195], v226 offset:0
    ds_read_b128 v[196:199], v226 offset:12288
    ds_read_b128 v[200:203], v227 offset:0
    ds_read_b128 v[204:207], v227 offset:12288
    ds_read_b128 v[208:211], v228 offset:0
    s_waitcnt lgkmcnt(4)
    v_mfma_f32_32x32x16_bf16 v[96:111], v[192:195], v[128:131], 0
    ds_read_b128 v[212:215], v228 offset:12288
    s_add_u32 s52, s28, s49
    s_add_u32 m0, s52, 0
    s_nop 0
    buffer_load_dwordx4 v216, s[12:15], s48 offen nt lds
    s_waitcnt lgkmcnt(4)
    v_mfma_f32_32x32x16_bf16 v[112:127], v[196:199], v[128:131], 0
    ds_read_b128 v[192:195], v229 offset:0
    s_waitcnt lgkmcnt(4)
    v_mfma_f32_32x32x16_bf16 v[96:111], v[200:203], v[132:135], v[96:111]
    ds_read_b128 v[196:199], v229 offset:12288
    s_add_u32 m0, s52, 1024
    s_nop 0
    buffer_load_dwordx4 v217, s[12:15], s48 offen nt lds
    s_waitcnt lgkmcnt(4)
    v_mfma_f32_32x32x16_bf16 v[112:127], v[204:207], v[132:135], v[112:127]
    ds_read_b128 v[200:203], v226 offset:128
    s_waitcnt lgkmcnt(4)
    v_mfma_f32_32x32x16_bf16 v[96:111], v[208:211], v[136:139], v[96:111]
    ds_read_b128 v[204:207], v226 offset:12416
    s_add_u32 m0, s52, 2048
    s_nop 0
    buffer_load_dwordx4 v218, s[12:15], s48 offen nt lds
    s_waitcnt lgkmcnt(4)
    v_mfma_f32_32x32x16_bf16 v[112:127], v[212:215], v[136:139], v[112:127]
    ds_read_b128 v[208:211], v227 offset:128
    s_waitcnt lgkmcnt(4)
    v_mfma_f32_32x32x16_bf16 v[96:111], v[192:195], v[140:143], v[96:111]
    ds_read_b128 v[212:215], v227 offset:12416
    s_add_u32 s52, s28, s49
    s_add_u32 s52, s52, 12288
    s_add_u32 s53, s48, 12288
    s_add_u32 m0, s52, 0
    s_nop 0
    buffer_load_dwordx4 v216, s[12:15], s53 offen nt lds
    s_waitcnt lgkmcnt(4)
    v_mfma_f32_32x32x16_bf16 v[112:127], v[196:199], v[140:143], v[112:127]
    ds_read_b128 v[192:195], v228 offset:128
    s_waitcnt lgkmcnt(4)
    v_mfma_f32_32x32x16_bf16 v[96:111], v[200:203], v[144:147], v[96:111]
    ds_read_b128 v[196:199], v228 offset:12416
    s_add_u32 m0, s52, 1024
    s_nop 0
    buffer_load_dwordx4 v217, s[12:15], s53 offen nt lds
    s_waitcnt lgkmcnt(4)
    v_mfma_f32_32x32x16_bf16 v[112:127], v[204:207], v[144:147], v[112:127]
    ds_read_b128 v[200:203], v229 offset:128
    s_waitcnt lgkmcnt(4)
    v_mfma_f32_32x32x16_bf16 v[96:111], v[208:211], v[148:151], v[96:111]
    ds_read_b128 v[204:207], v229 offset:12416
    s_add_u32 m0, s52, 2048
    s_nop 0
    buffer_load_dwordx4 v218, s[12:15], s53 offen nt lds
    s_waitcnt lgkmcnt(4)
    v_mfma_f32_32x32x16_bf16 v[112:127], v[212:215], v[148:151], v[112:127]
    ds_read_b128 v[208:211], v226 offset:256
    s_waitcnt lgkmcnt(4)
    v_mfma_f32_32x32x16_bf16 v[96:111], v[192:195], v[152:155], v[96:111]
    ds_read_b128 v[212:215], v226 offset:12544
    s_waitcnt lgkmcnt(4)
    v_mfma_f32_32x32x16_bf16 v[112:127], v[196:199], v[152:155], v[112:127]
    ds_read_b128 v[192:195], v227 offset:256
    s_waitcnt lgkmcnt(4)
    v_mfma_f32_32x32x16_bf16 v[96:111], v[200:203], v[156:159], v[96:111]
    ds_read_b128 v[196:199], v227 offset:12544
    s_waitcnt lgkmcnt(4)
    v_mfma_f32_32x32x16_bf16 v[112:127], v[204:207], v[156:159], v[112:127]
    ds_read_b128 v[200:203], v228 offset:256
    s_waitcnt lgkmcnt(4)
    v_mfma_f32_32x32x16_bf16 v[96:111], v[208:211], v[160:163], v[96:111]
    ds_read_b128 v[204:207], v228 offset:12544
    s_waitcnt lgkmcnt(4)
    v_mfma_f32_32x32x16_bf16 v[112:127], v[212:215], v[160:163], v[112:127]
    ds_read_b128 v[208:211], v229 offset:256
    s_waitcnt lgkmcnt(4)
    v_mfma_f32_32x32x16_bf16 v[96:111], v[192:195], v[164:167], v[96:111]
    ds_read_b128 v[212:215], v229 offset:12544
    s_waitcnt lgkmcnt(4)
    v_mfma_f32_32x32x16_bf16 v[112:127], v[196:199], v[164:167], v[112:127]
    s_waitcnt lgkmcnt(3)
    v_mfma_f32_32x32x16_bf16 v[96:111], v[200:203], v[168:171], v[96:111]
    s_waitcnt lgkmcnt(2)
    v_mfma_f32_32x32x16_bf16 v[112:127], v[204:207], v[168:171], v[112:127]
    s_waitcnt lgkmcnt(1)
    v_mfma_f32_32x32x16_bf16 v[96:111], v[208:211], v[172:175], v[96:111]
    s_waitcnt lgkmcnt(0)
    v_mfma_f32_32x32x16_bf16 v[112:127], v[212:215], v[172:175], v[112:127]
    s_mov_b32 s52, s26
    s_mov_b32 s26, s27
    s_mov_b32 s27, s28
    s_mov_b32 s28, s52
    s_nop 7
    s_nop 0
    v_max3_f32 v241, v96, v97, v98
    v_max3_f32 v241, v241, v99, v100
    v_max3_f32 v241, v241, v101, v102
    v_max3_f32 v241, v241, v103, v104
    v_max3_f32 v241, v241, v105, v106
    v_max3_f32 v241, v241, v107, v108
    v_max3_f32 v241, v241, v109, v110
    v_max3_f32 v242, v111, v112, v113
    v_max3_f32 v242, v242, v114, v115
    v_max3_f32 v242, v242, v116, v117
    v_max3_f32 v242, v242, v118, v119
    v_max3_f32 v242, v242, v120, v121
    v_max3_f32 v242, v242, v122, v123
    v_max3_f32 v242, v242, v124, v125
    v_max3_f32 v242, v242, v126, v127
    v_max_f32 v241, v241, v242
    v_mov_b32 v242, v241
    s_nop 1
    v_permlane32_swap_b32 v241, v242
    s_nop 1
    v_max_f32 v241, v241, v242
    v_sub_f32 v242, v241, v234
    v_cmp_lt_f32 vcc, 0x4299ac27, v242
    s_cbranch_vccz K1_NORESCa
    v_max_f32 v241, v241, v234
    v_sub_f32 v242, v234, v241
    v_mul_f32 v242, s51, v242
    v_exp_f32 v240, v242
    v_mov_b32 v234, v241
    v_mul_f32 v235, s51, v241
    v_sub_f32 v235, 0, v235
    v_mul_f32 v236, v236, v240
    v_mul_f32 v237, v237, v240
    v_mul_f32 v238, v238, v240
    v_mul_f32 v239, v239, v240
    v_mul_f32 v0, v0, v240
    v_mul_f32 v1, v1, v240
    v_mul_f32 v2, v2, v240
    v_mul_f32 v3, v3, v240
    v_mul_f32 v4, v4, v240
    v_mul_f32 v5, v5, v240
    v_mul_f32 v6, v6, v240
    v_mul_f32 v7, v7, v240
    v_mul_f32 v8, v8, v240
    v_mul_f32 v9, v9, v240
    v_mul_f32 v10, v10, v240
    v_mul_f32 v11, v11, v240
    v_mul_f32 v12, v12, v240
    v_mul_f32 v13, v13, v240
    v_mul_f32 v14, v14, v240
    v_mul_f32 v15, v15, v240
    v_mul_f32 v16, v16, v240
    v_mul_f32 v17, v17, v240
    v_mul_f32 v18, v18, v240
    v_mul_f32 v19, v19, v240
    v_mul_f32 v20, v20, v240
    v_mul_f32 v21, v21, v240
    v_mul_f32 v22, v22, v240
    v_mul_f32 v23, v23, v240
    v_mul_f32 v24, v24, v240
    v_mul_f32 v25, v25, v240
    v_mul_f32 v26, v26, v240
    v_mul_f32 v27, v27, v240
    v_mul_f32 v28, v28, v240
    v_mul_f32 v29, v29, v240
    v_mul_f32 v30, v30, v240
    v_mul_f32 v31, v31, v240
    v_mul_f32 v32, v32, v240
    v_mul_f32 v33, v33, v240
    v_mul_f32 v34, v34, v240
    v_mul_f32 v35, v35, v240
    v_mul_f32 v36, v36, v240
    v_mul_f32 v37, v37, v240
    v_mul_f32 v38, v38, v240
    v_mul_f32 v39, v39, v240
    v_mul_f32 v40, v40, v240
    v_mul_f32 v41, v41, v240
    v_mul_f32 v42, v42, v240
    v_mul_f32 v43, v43, v240
    v_mul_f32 v44, v44, v240
    v_mul_f32 v45, v45, v240
    v_mul_f32 v46, v46, v240
    v_mul_f32 v47, v47, v240
    v_mul_f32 v48, v48, v240
    v_mul_f32 v49, v49, v240
    v_mul_f32 v50, v50, v240
    v_mul_f32 v51, v51, v240
    v_mul_f32 v52, v52, v240
    v_mul_f32 v53, v53, v240
    v_mul_f32 v54, v54, v240
    v_mul_f32 v55, v55, v240
    v_mul_f32 v56, v56, v240
    v_mul_f32 v57, v57, v240
    v_mul_f32 v58, v58, v240
    v_mul_f32 v59, v59, v240
    v_mul_f32 v60, v60, v240
    v_mul_f32 v61, v61, v240
    v_mul_f32 v62, v62, v240
    v_mul_f32 v63, v63, v240
    v_mul_f32 v64, v64, v240
    v_mul_f32 v65, v65, v240
    v_mul_f32 v66, v66, v240
    v_mul_f32 v67, v67, v240
    v_mul_f32 v68, v68, v240
    v_mul_f32 v69, v69, v240
    v_mul_f32 v70, v70, v240
    v_mul_f32 v71, v71, v240
    v_mul_f32 v72, v72, v240
    v_mul_f32 v73, v73, v240
    v_mul_f32 v74, v74, v240
    v_mul_f32 v75, v75, v240
    v_mul_f32 v76, v76, v240
    v_mul_f32 v77, v77, v240
    v_mul_f32 v78, v78, v240
    v_mul_f32 v79, v79, v240
    v_mul_f32 v80, v80, v240
    v_mul_f32 v81, v81, v240
    v_mul_f32 v82, v82, v240
    v_mul_f32 v83, v83, v240
    v_mul_f32 v84, v84, v240
    v_mul_f32 v85, v85, v240
    v_mul_f32 v86, v86, v240
    v_mul_f32 v87, v87, v240
    v_mul_f32 v88, v88, v240
    v_mul_f32 v89, v89, v240
    v_mul_f32 v90, v90, v240
    v_mul_f32 v91, v91, v240
    v_mul_f32 v92, v92, v240
    v_mul_f32 v93, v93, v240
    v_mul_f32 v94, v94, v240
    v_mul_f32 v95, v95, v240
K1_NORESCa:
    v_fma_f32 v96, v96, s51, v235
    v_fma_f32 v97, v97, s51, v235
    v_fma_f32 v98, v98, s51, v235
    v_fma_f32 v99, v99, s51, v235
    v_exp_f32 v96, v96
    v_exp_f32 v97, v97
    v_fma_f32 v100, v100, s51, v235
    v_fma_f32 v101, v101, s51, v235
    v_exp_f32 v98, v98
    v_exp_f32 v99, v99
    v_add_f32 v236, v236, v96
    v_add_f32 v237, v237, v97
    v_cvt_pk_bf16_f32 v176, v96, v97
    v_fma_f32 v102, v102, s51, v235
    v_fma_f32 v103, v103, s51, v235
    v_exp_f32 v100, v100
    v_exp_f32 v101, v101
    v_add_f32 v238, v238, v98
    v_add_f32 v239, v239, v99
    v_cvt_pk_bf16_f32 v177, v98, v99
    v_fma_f32 v104, v104, s51, v235
    v_fma_f32 v105, v105, s51, v235
    v_exp_f32 v102, v102
    v_exp_f32 v103, v103
    v_add_f32 v236, v236, v100
    v_add_f32 v237, v237, v101
    v_cvt_pk_bf16_f32 v178, v100, v101
    v_fma_f32 v106, v106, s51, v235
    v_fma_f32 v107, v107, s51, v235
    v_exp_f32 v104, v104
    v_exp_f32 v105, v105
    v_add_f32 v238, v238, v102
    v_add_f32 v239, v239, v103
    v_cvt_pk_bf16_f32 v179, v102, v103
    v_fma_f32 v108, v108, s51, v235
    v_fma_f32 v109, v109, s51, v235
    v_exp_f32 v106, v106
    v_exp_f32 v107, v107
    v_add_f32 v236, v236, v104
    v_add_f32 v237, v237, v105
    v_cvt_pk_bf16_f32 v180, v104, v105
    v_fma_f32 v110, v110, s51, v235
    v_fma_f32 v111, v111, s51, v235
    v_exp_f32 v108, v108
    v_exp_f32 v109, v109
    v_add_f32 v238, v238, v106
    v_add_f32 v239, v239, v107
    v_cvt_pk_bf16_f32 v181, v106, v107
    v_fma_f32 v112, v112, s51, v235
    v_fma_f32 v113, v113, s51, v235
    v_exp_f32 v110, v110
    v_exp_f32 v111, v111
    v_add_f32 v236, v236, v108
    v_add_f32 v237, v237, v109
    v_cvt_pk_bf16_f32 v182, v108, v109
    v_fma_f32 v114, v114, s51, v235
    v_fma_f32 v115, v115, s51, v235
    v_exp_f32 v112, v112
    v_exp_f32 v113, v113
    v_add_f32 v238, v238, v110
    v_add_f32 v239, v239, v111
    v_cvt_pk_bf16_f32 v183, v110, v111
    v_fma_f32 v116, v116, s51, v235
    v_fma_f32 v117, v117, s51, v235
    v_exp_f32 v114, v114
    v_exp_f32 v115, v115
    v_add_f32 v236, v236, v112
    v_add_f32 v237, v237, v113
    v_cvt_pk_bf16_f32 v184, v112, v113
    v_fma_f32 v118, v118, s51, v235
    v_fma_f32 v119, v119, s51, v235
    v_exp_f32 v116, v116
    v_exp_f32 v117, v117
    v_add_f32 v238, v238, v114
    v_add_f32 v239, v239, v115
    v_cvt_pk_bf16_f32 v185, v114, v115
    v_fma_f32 v120, v120, s51, v235
    v_fma_f32 v121, v121, s51, v235
    v_exp_f32 v118, v118
    v_exp_f32 v119, v119
    v_add_f32 v236, v236, v116
    v_add_f32 v237, v237, v117
    v_cvt_pk_bf16_f32 v186, v116, v117
    v_fma_f32 v122, v122, s51, v235
    v_fma_f32 v123, v123, s51, v235
    v_exp_f32 v120, v120
    v_exp_f32 v121, v121
    v_add_f32 v238, v238, v118
    v_add_f32 v239, v239, v119
    v_cvt_pk_bf16_f32 v187, v118, v119
    v_fma_f32 v124, v124, s51, v235
    v_fma_f32 v125, v125, s51, v235
    v_exp_f32 v122, v122
    v_exp_f32 v123, v123
    v_add_f32 v236, v236, v120
    v_add_f32 v237, v237, v121
    v_cvt_pk_bf16_f32 v188, v120, v121
    v_fma_f32 v126, v126, s51, v235
    v_fma_f32 v127, v127, s51, v235
    v_exp_f32 v124, v124
    v_exp_f32 v125, v125
    v_add_f32 v238, v238, v122
    v_add_f32 v239, v239, v123
    v_cvt_pk_bf16_f32 v189, v122, v123
    v_exp_f32 v126, v126
    v_exp_f32 v127, v127
    v_add_f32 v236, v236, v124
    v_add_f32 v237, v237, v125
    v_cvt_pk_bf16_f32 v190, v124, v125
    s_nop 0
    v_add_f32 v238, v238, v126
    v_add_f32 v239, v239, v127
    v_cvt_pk_bf16_f32 v191, v126, v127
    s_waitcnt vmcnt(6)
    s_barrier
    v_add_u32 v232, s26, v230
    v_add_u32 v233, s26, v231
    ds_read_b64_tr_b16 v[192:193], v232 offset:0
    ds_read_b64_tr_b16 v[194:195], v232 offset:3072
    ds_read_b64_tr_b16 v[196:197], v233 offset:64
    ds_read_b64_tr_b16 v[198:199], v233 offset:3136
    ds_read_b64_tr_b16 v[200:201], v232 offset:128
    ds_read_b64_tr_b16 v[202:203], v232 offset:3200
    ds_read_b64_tr_b16 v[204:205], v233 offset:192
    ds_read_b64_tr_b16 v[206:207], v233 offset:3264
    ds_read_b64_tr_b16 v[208:209], v232 offset:256
    ds_read_b64_tr_b16 v[210:211], v232 offset:3328
    s_waitcnt lgkmcnt(8)
    v_mfma_f32_32x32x16_bf16 v[0:15], v[192:195], v[176:179], v[0:15]
    ds_read_b64_tr_b16 v[212:213], v233 offset:320
    ds_read_b64_tr_b16 v[214:215], v233 offset:3392
    s_add_u32 s52, s28, s49
    s_add_u32 m0, s52, 0
    s_nop 0
    buffer_load_dwordx4 v219, s[16:19], s48 offen nt lds
    s_waitcnt lgkmcnt(8)
    v_mfma_f32_32x32x16_bf16 v[16:31], v[196:199], v[176:179], v[16:31]
    ds_read_b64_tr_b16 v[192:193], v232 offset:6144
    ds_read_b64_tr_b16 v[194:195], v232 offset:9216
    s_waitcnt lgkmcnt(8)
    v_mfma_f32_32x32x16_bf16 v[32:47], v[200:203], v[176:179], v[32:47]
    ds_read_b64_tr_b16 v[196:197], v233 offset:6208
    ds_read_b64_tr_b16 v[198:199], v233 offset:9280
    s_add_u32 m0, s52, 1024
    s_nop 0
    buffer_load_dwordx4 v220, s[16:19], s48 offen nt lds
    s_waitcnt lgkmcnt(8)
    v_mfma_f32_32x32x16_bf16 v[48:63], v[204:207], v[176:179], v[48:63]
    ds_read_b64_tr_b16 v[200:201], v232 offset:6272
    ds_read_b64_tr_b16 v[202:203], v232 offset:9344
    s_waitcnt lgkmcnt(8)
    v_mfma_f32_32x32x16_bf16 v[64:79], v[208:211], v[176:179], v[64:79]
    ds_read_b64_tr_b16 v[204:205], v233 offset:6336
    ds_read_b64_tr_b16 v[206:207], v233 offset:9408
    s_add_u32 m0, s52, 2048
    s_nop 0
    buffer_load_dwordx4 v221, s[16:19], s48 offen nt lds
    s_waitcnt lgkmcnt(8)
    v_mfma_f32_32x32x16_bf16 v[80:95], v[212:215], v[176:179], v[80:95]
    ds_read_b64_tr_b16 v[208:209], v232 offset:6400
    ds_read_b64_tr_b16 v[210:211], v232 offset:9472
    s_waitcnt lgkmcnt(8)
    v_mfma_f32_32x32x16_bf16 v[0:15], v[192:195], v[180:183], v[0:15]
    ds_read_b64_tr_b16 v[212:213], v233 offset:6464
    ds_read_b64_tr_b16 v[214:215], v233 offset:9536
    s_add_u32 s52, s28, s49
    s_add_u32 s52, s52, 12288
    s_add_u32 s53, s48, 12288
    s_add_u32 m0, s52, 0
    s_nop 0
    buffer_load_dwordx4 v219, s[16:19], s53 offen nt lds
    s_waitcnt lgkmcnt(8)
    v_mfma_f32_32x32x16_bf16 v[16:31], v[196:199], v[180:183], v[16:31]
    ds_read_b64_tr_b16 v[192:193], v232 offset:12288
    ds_read_b64_tr_b16 v[194:195], v232 offset:15360
    s_waitcnt lgkmcnt(8)
    v_mfma_f32_32x32x16_bf16 v[32:47], v[200:203], v[180:183], v[32:47]
    ds_read_b64_tr_b16 v[196:197], v233 offset:12352
    ds_read_b64_tr_b16 v[198:199], v233 offset:15424
    s_add_u32 m0, s52, 1024
    s_nop 0
    buffer_load_dwordx4 v220, s[16:19], s53 offen nt lds
    s_waitcnt lgkmcnt(8)
    v_mfma_f32_32x32x16_bf16 v[48:63], v[204:207], v[180:183], v[48:63]
    ds_read_b64_tr_b16 v[200:201], v232 offset:12416
    ds_read_b64_tr_b16 v[202:203], v232 offset:15488
    s_waitcnt lgkmcnt(8)
    v_mfma_f32_32x32x16_bf16 v[64:79], v[208:211], v[180:183], v[64:79]
    ds_read_b64_tr_b16 v[204:205], v233 offset:12480
    ds_read_b64_tr_b16 v[206:207], v233 offset:15552
    s_add_u32 m0, s52, 2048
    s_nop 0
    buffer_load_dwordx4 v221, s[16:19], s53 offen nt lds
    s_add_u32 s48, s48, 24576
    s_waitcnt lgkmcnt(8)
    v_mfma_f32_32x32x16_bf16 v[80:95], v[212:215], v[180:183], v[80:95]
    ds_read_b64_tr_b16 v[208:209], v232 offset:12544
    ds_read_b64_tr_b16 v[210:211], v232 offset:15616
    s_waitcnt lgkmcnt(8)
    v_mfma_f32_32x32x16_bf16 v[0:15], v[192:195], v[184:187], v[0:15]
    ds_read_b64_tr_b16 v[212:213], v233 offset:12608
    ds_read_b64_tr_b16 v[214:215], v233 offset:15680
    s_waitcnt lgkmcnt(8)
    v_mfma_f32_32x32x16_bf16 v[16:31], v[196:199], v[184:187], v[16:31]
    ds_read_b64_tr_b16 v[192:193], v232 offset:18432
    ds_read_b64_tr_b16 v[194:195], v232 offset:21504
    s_waitcnt lgkmcnt(8)
    v_mfma_f32_32x32x16_bf16 v[32:47], v[200:203], v[184:187], v[32:47]
    ds_read_b64_tr_b16 v[196:197], v233 offset:18496
    ds_read_b64_tr_b16 v[198:199], v233 offset:21568
    s_waitcnt lgkmcnt(8)
    v_mfma_f32_32x32x16_bf16 v[48:63], v[204:207], v[184:187], v[48:63]
    ds_read_b64_tr_b16 v[200:201], v232 offset:18560
    ds_read_b64_tr_b16 v[202:203], v232 offset:21632
    s_waitcnt lgkmcnt(8)
    v_mfma_f32_32x32x16_bf16 v[64:79], v[208:211], v[184:187], v[64:79]
    ds_read_b64_tr_b16 v[204:205], v233 offset:18624
    ds_read_b64_tr_b16 v[206:207], v233 offset:21696
    s_waitcnt lgkmcnt(8)
    v_mfma_f32_32x32x16_bf16 v[80:95], v[212:215], v[184:187], v[80:95]
    ds_read_b64_tr_b16 v[208:209], v232 offset:18688
    ds_read_b64_tr_b16 v[210:211], v232 offset:21760
    s_waitcnt lgkmcnt(8)
    v_mfma_f32_32x32x16_bf16 v[0:15], v[192:195], v[188:191], v[0:15]
    ds_read_b64_tr_b16 v[212:213], v233 offset:18752
    ds_read_b64_tr_b16 v[214:215], v233 offset:21824
    s_waitcnt lgkmcnt(8)
    v_mfma_f32_32x32x16_bf16 v[16:31], v[196:199], v[188:191], v[16:31]
    s_waitcnt lgkmcnt(6)
    v_mfma_f32_32x32x16_bf16 v[32:47], v[200:203], v[188:191], v[32:47]
    s_waitcnt lgkmcnt(4)
    v_mfma_f32_32x32x16_bf16 v[48:63], v[204:207], v[188:191], v[48:63]
    s_waitcnt lgkmcnt(2)
    v_mfma_f32_32x32x16_bf16 v[64:79], v[208:211], v[188:191], v[64:79]
    s_waitcnt lgkmcnt(0)
    v_mfma_f32_32x32x16_bf16 v[80:95], v[212:215], v[188:191], v[80:95]
    s_mov_b32 s52, s26
    s_mov_b32 s26, s27
    s_mov_b32 s27, s28
    s_mov_b32 s28, s52
    s_sub_u32 s29, s29, 1
    s_cmp_lg_u32 s29, 0
    s_cbranch_scc1 K1_KVLOOP
    s_waitcnt vmcnt(6)
    s_barrier
    v_add_u32 v226, s26, v222
    v_add_u32 v227, s26, v223
    v_add_u32 v228, s26, v224
    v_add_u32 v229, s26, v225
    ds_read_b128 v[192:195], v226 offset:0
    ds_read_b128 v[196:199], v226 offset:12288
    ds_read_b128 v[200:203], v227 offset:0
    ds_read_b128 v[204:207], v227 offset:12288
    ds_read_b128 v[208:211], v228 offset:0
    s_waitcnt lgkmcnt(4)
    v_mfma_f32_32x32x16_bf16 v[96:111], v[192:195], v[128:131], 0
    ds_read_b128 v[212:215], v228 offset:12288
    s_waitcnt lgkmcnt(4)
    v_mfma_f32_32x32x16_bf16 v[112:127], v[196:199], v[128:131], 0
    ds_read_b128 v[192:195], v229 offset:0
    s_waitcnt lgkmcnt(4)
    v_mfma_f32_32x32x16_bf16 v[96:111], v[200:203], v[132:135], v[96:111]
    ds_read_b128 v[196:199], v229 offset:12288
    s_waitcnt lgkmcnt(4)
    v_mfma_f32_32x32x16_bf16 v[112:127], v[204:207], v[132:135], v[112:127]
    ds_read_b128 v[200:203], v226 offset:128
    s_waitcnt lgkmcnt(4)
    v_mfma_f32_32x32x16_bf16 v[96:111], v[208:211], v[136:139], v[96:111]
    ds_read_b128 v[204:207], v226 offset:12416
    s_waitcnt lgkmcnt(4)
    v_mfma_f32_32x32x16_bf16 v[112:127], v[212:215], v[136:139], v[112:127]
    ds_read_b128 v[208:211], v227 offset:128
    s_waitcnt lgkmcnt(4)
    v_mfma_f32_32x32x16_bf16 v[96:111], v[192:195], v[140:143], v[96:111]
    ds_read_b128 v[212:215], v227 offset:12416
    s_waitcnt lgkmcnt(4)
    v_mfma_f32_32x32x16_bf16 v[112:127], v[196:199], v[140:143], v[112:127]
    ds_read_b128 v[192:195], v228 offset:128
    s_waitcnt lgkmcnt(4)
    v_mfma_f32_32x32x16_bf16 v[96:111], v[200:203], v[144:147], v[96:111]
    ds_read_b128 v[196:199], v228 offset:12416
    s_waitcnt lgkmcnt(4)
    v_mfma_f32_32x32x16_bf16 v[112:127], v[204:207], v[144:147], v[112:127]
    ds_read_b128 v[200:203], v229 offset:128
    s_waitcnt lgkmcnt(4)
    v_mfma_f32_32x32x16_bf16 v[96:111], v[208:211], v[148:151], v[96:111]
    ds_read_b128 v[204:207], v229 offset:12416
    s_waitcnt lgkmcnt(4)
    v_mfma_f32_32x32x16_bf16 v[112:127], v[212:215], v[148:151], v[112:127]
    ds_read_b128 v[208:211], v226 offset:256
    s_waitcnt lgkmcnt(4)
    v_mfma_f32_32x32x16_bf16 v[96:111], v[192:195], v[152:155], v[96:111]
    ds_read_b128 v[212:215], v226 offset:12544
    s_waitcnt lgkmcnt(4)
    v_mfma_f32_32x32x16_bf16 v[112:127], v[196:199], v[152:155], v[112:127]
    ds_read_b128 v[192:195], v227 offset:256
    s_waitcnt lgkmcnt(4)
    v_mfma_f32_32x32x16_bf16 v[96:111], v[200:203], v[156:159], v[96:111]
    ds_read_b128 v[196:199], v227 offset:12544
    s_waitcnt lgkmcnt(4)
    v_mfma_f32_32x32x16_bf16 v[112:127], v[204:207], v[156:159], v[112:127]
    ds_read_b128 v[200:203], v228 offset:256
    s_waitcnt lgkmcnt(4)
    v_mfma_f32_32x32x16_bf16 v[96:111], v[208:211], v[160:163], v[96:111]
    ds_read_b128 v[204:207], v228 offset:12544
    s_waitcnt lgkmcnt(4)
    v_mfma_f32_32x32x16_bf16 v[112:127], v[212:215], v[160:163], v[112:127]
    ds_read_b128 v[208:211], v229 offset:256
    s_waitcnt lgkmcnt(4)
    v_mfma_f32_32x32x16_bf16 v[96:111], v[192:195], v[164:167], v[96:111]
    ds_read_b128 v[212:215], v229 offset:12544
    s_waitcnt lgkmcnt(4)
    v_mfma_f32_32x32x16_bf16 v[112:127], v[196:199], v[164:167], v[112:127]
    s_waitcnt lgkmcnt(3)
    v_mfma_f32_32x32x16_bf16 v[96:111], v[200:203], v[168:171], v[96:111]
    s_waitcnt lgkmcnt(2)
    v_mfma_f32_32x32x16_bf16 v[112:127], v[204:207], v[168:171], v[112:127]
    s_waitcnt lgkmcnt(1)
    v_mfma_f32_32x32x16_bf16 v[96:111], v[208:211], v[172:175], v[96:111]
    s_waitcnt lgkmcnt(0)
    v_mfma_f32_32x32x16_bf16 v[112:127], v[212:215], v[172:175], v[112:127]
    s_mov_b32 s52, s26
    s_mov_b32 s26, s27
    s_mov_b32 s27, s28
    s_mov_b32 s28, s52
    s_nop 7
    s_nop 0
    v_max3_f32 v241, v96, v97, v98
    v_max3_f32 v241, v241, v99, v100
    v_max3_f32 v241, v241, v101, v102
    v_max3_f32 v241, v241, v103, v104
    v_max3_f32 v241, v241, v105, v106
    v_max3_f32 v241, v241, v107, v108
    v_max3_f32 v241, v241, v109, v110
    v_max3_f32 v242, v111, v112, v113
    v_max3_f32 v242, v242, v114, v115
    v_max3_f32 v242, v242, v116, v117
    v_max3_f32 v242, v242, v118, v119
    v_max3_f32 v242, v242, v120, v121
    v_max3_f32 v242, v242, v122, v123
    v_max3_f32 v242, v242, v124, v125
    v_max3_f32 v242, v242, v126, v127
    v_max_f32 v241, v241, v242
    v_mov_b32 v242, v241
    s_nop 1
    v_permlane32_swap_b32 v241, v242
    s_nop 1
    v_max_f32 v241, v241, v242
    v_sub_f32 v242, v241, v234
    v_cmp_lt_f32 vcc, 0x4299ac27, v242
    s_cbranch_vccz K1_NORESCb
    v_max_f32 v241, v241, v234
    v_sub_f32 v242, v234, v241
    v_mul_f32 v242, s51, v242
    v_exp_f32 v240, v242
    v_mov_b32 v234, v241
    v_mul_f32 v235, s51, v241
    v_sub_f32 v235, 0, v235
    v_mul_f32 v236, v236, v240
    v_mul_f32 v237, v237, v240
    v_mul_f32 v238, v238, v240
    v_mul_f32 v239, v239, v240
    v_mul_f32 v0, v0, v240
    v_mul_f32 v1, v1, v240
    v_mul_f32 v2, v2, v240
    v_mul_f32 v3, v3, v240
    v_mul_f32 v4, v4, v240
    v_mul_f32 v5, v5, v240
    v_mul_f32 v6, v6, v240
    v_mul_f32 v7, v7, v240
    v_mul_f32 v8, v8, v240
    v_mul_f32 v9, v9, v240
    v_mul_f32 v10, v10, v240
    v_mul_f32 v11, v11, v240
    v_mul_f32 v12, v12, v240
    v_mul_f32 v13, v13, v240
    v_mul_f32 v14, v14, v240
    v_mul_f32 v15, v15, v240
    v_mul_f32 v16, v16, v240
    v_mul_f32 v17, v17, v240
    v_mul_f32 v18, v18, v240
    v_mul_f32 v19, v19, v240
    v_mul_f32 v20, v20, v240
    v_mul_f32 v21, v21, v240
    v_mul_f32 v22, v22, v240
    v_mul_f32 v23, v23, v240
    v_mul_f32 v24, v24, v240
    v_mul_f32 v25, v25, v240
    v_mul_f32 v26, v26, v240
    v_mul_f32 v27, v27, v240
    v_mul_f32 v28, v28, v240
    v_mul_f32 v29, v29, v240
    v_mul_f32 v30, v30, v240
    v_mul_f32 v31, v31, v240
    v_mul_f32 v32, v32, v240
    v_mul_f32 v33, v33, v240
    v_mul_f32 v34, v34, v240
    v_mul_f32 v35, v35, v240
    v_mul_f32 v36, v36, v240
    v_mul_f32 v37, v37, v240
    v_mul_f32 v38, v38, v240
    v_mul_f32 v39, v39, v240
    v_mul_f32 v40, v40, v240
    v_mul_f32 v41, v41, v240
    v_mul_f32 v42, v42, v240
    v_mul_f32 v43, v43, v240
    v_mul_f32 v44, v44, v240
    v_mul_f32 v45, v45, v240
    v_mul_f32 v46, v46, v240
    v_mul_f32 v47, v47, v240
    v_mul_f32 v48, v48, v240
    v_mul_f32 v49, v49, v240
    v_mul_f32 v50, v50, v240
    v_mul_f32 v51, v51, v240
    v_mul_f32 v52, v52, v240
    v_mul_f32 v53, v53, v240
    v_mul_f32 v54, v54, v240
    v_mul_f32 v55, v55, v240
    v_mul_f32 v56, v56, v240
    v_mul_f32 v57, v57, v240
    v_mul_f32 v58, v58, v240
    v_mul_f32 v59, v59, v240
    v_mul_f32 v60, v60, v240
    v_mul_f32 v61, v61, v240
    v_mul_f32 v62, v62, v240
    v_mul_f32 v63, v63, v240
    v_mul_f32 v64, v64, v240
    v_mul_f32 v65, v65, v240
    v_mul_f32 v66, v66, v240
    v_mul_f32 v67, v67, v240
    v_mul_f32 v68, v68, v240
    v_mul_f32 v69, v69, v240
    v_mul_f32 v70, v70, v240
    v_mul_f32 v71, v71, v240
    v_mul_f32 v72, v72, v240
    v_mul_f32 v73, v73, v240
    v_mul_f32 v74, v74, v240
    v_mul_f32 v75, v75, v240
    v_mul_f32 v76, v76, v240
    v_mul_f32 v77, v77, v240
    v_mul_f32 v78, v78, v240
    v_mul_f32 v79, v79, v240
    v_mul_f32 v80, v80, v240
    v_mul_f32 v81, v81, v240
    v_mul_f32 v82, v82, v240
    v_mul_f32 v83, v83, v240
    v_mul_f32 v84, v84, v240
    v_mul_f32 v85, v85, v240
    v_mul_f32 v86, v86, v240
    v_mul_f32 v87, v87, v240
    v_mul_f32 v88, v88, v240
    v_mul_f32 v89, v89, v240
    v_mul_f32 v90, v90, v240
    v_mul_f32 v91, v91, v240
    v_mul_f32 v92, v92, v240
    v_mul_f32 v93, v93, v240
    v_mul_f32 v94, v94, v240
    v_mul_f32 v95, v95, v240
K1_NORESCb:
    v_fma_f32 v96, v96, s51, v235
    v_fma_f32 v97, v97, s51, v235
    v_fma_f32 v98, v98, s51, v235
    v_fma_f32 v99, v99, s51, v235
    v_exp_f32 v96, v96
    v_exp_f32 v97, v97
    v_fma_f32 v100, v100, s51, v235
    v_fma_f32 v101, v101, s51, v235
    v_exp_f32 v98, v98
    v_exp_f32 v99, v99
    v_add_f32 v236, v236, v96
    v_add_f32 v237, v237, v97
    v_cvt_pk_bf16_f32 v176, v96, v97
    v_fma_f32 v102, v102, s51, v235
    v_fma_f32 v103, v103, s51, v235
    v_exp_f32 v100, v100
    v_exp_f32 v101, v101
    v_add_f32 v238, v238, v98
    v_add_f32 v239, v239, v99
    v_cvt_pk_bf16_f32 v177, v98, v99
    v_fma_f32 v104, v104, s51, v235
    v_fma_f32 v105, v105, s51, v235
    v_exp_f32 v102, v102
    v_exp_f32 v103, v103
    v_add_f32 v236, v236, v100
    v_add_f32 v237, v237, v101
    v_cvt_pk_bf16_f32 v178, v100, v101
    v_fma_f32 v106, v106, s51, v235
    v_fma_f32 v107, v107, s51, v235
    v_exp_f32 v104, v104
    v_exp_f32 v105, v105
    v_add_f32 v238, v238, v102
    v_add_f32 v239, v239, v103
    v_cvt_pk_bf16_f32 v179, v102, v103
    v_fma_f32 v108, v108, s51, v235
    v_fma_f32 v109, v109, s51, v235
    v_exp_f32 v106, v106
    v_exp_f32 v107, v107
    v_add_f32 v236, v236, v104
    v_add_f32 v237, v237, v105
    v_cvt_pk_bf16_f32 v180, v104, v105
    v_fma_f32 v110, v110, s51, v235
    v_fma_f32 v111, v111, s51, v235
    v_exp_f32 v108, v108
    v_exp_f32 v109, v109
    v_add_f32 v238, v238, v106
    v_add_f32 v239, v239, v107
    v_cvt_pk_bf16_f32 v181, v106, v107
    v_fma_f32 v112, v112, s51, v235
    v_fma_f32 v113, v113, s51, v235
    v_exp_f32 v110, v110
    v_exp_f32 v111, v111
    v_add_f32 v236, v236, v108
    v_add_f32 v237, v237, v109
    v_cvt_pk_bf16_f32 v182, v108, v109
    v_fma_f32 v114, v114, s51, v235
    v_fma_f32 v115, v115, s51, v235
    v_exp_f32 v112, v112
    v_exp_f32 v113, v113
    v_add_f32 v238, v238, v110
    v_add_f32 v239, v239, v111
    v_cvt_pk_bf16_f32 v183, v110, v111
    v_fma_f32 v116, v116, s51, v235
    v_fma_f32 v117, v117, s51, v235
    v_exp_f32 v114, v114
    v_exp_f32 v115, v115
    v_add_f32 v236, v236, v112
    v_add_f32 v237, v237, v113
    v_cvt_pk_bf16_f32 v184, v112, v113
    v_fma_f32 v118, v118, s51, v235
    v_fma_f32 v119, v119, s51, v235
    v_exp_f32 v116, v116
    v_exp_f32 v117, v117
    v_add_f32 v238, v238, v114
    v_add_f32 v239, v239, v115
    v_cvt_pk_bf16_f32 v185, v114, v115
    v_fma_f32 v120, v120, s51, v235
    v_fma_f32 v121, v121, s51, v235
    v_exp_f32 v118, v118
    v_exp_f32 v119, v119
    v_add_f32 v236, v236, v116
    v_add_f32 v237, v237, v117
    v_cvt_pk_bf16_f32 v186, v116, v117
    v_fma_f32 v122, v122, s51, v235
    v_fma_f32 v123, v123, s51, v235
    v_exp_f32 v120, v120
    v_exp_f32 v121, v121
    v_add_f32 v238, v238, v118
    v_add_f32 v239, v239, v119
    v_cvt_pk_bf16_f32 v187, v118, v119
    v_fma_f32 v124, v124, s51, v235
    v_fma_f32 v125, v125, s51, v235
    v_exp_f32 v122, v122
    v_exp_f32 v123, v123
    v_add_f32 v236, v236, v120
    v_add_f32 v237, v237, v121
    v_cvt_pk_bf16_f32 v188, v120, v121
    v_fma_f32 v126, v126, s51, v235
    v_fma_f32 v127, v127, s51, v235
    v_exp_f32 v124, v124
    v_exp_f32 v125, v125
    v_add_f32 v238, v238, v122
    v_add_f32 v239, v239, v123
    v_cvt_pk_bf16_f32 v189, v122, v123
    v_exp_f32 v126, v126
    v_exp_f32 v127, v127
    v_add_f32 v236, v236, v124
    v_add_f32 v237, v237, v125
    v_cvt_pk_bf16_f32 v190, v124, v125
    s_nop 0
    v_add_f32 v238, v238, v126
    v_add_f32 v239, v239, v127
    v_cvt_pk_bf16_f32 v191, v126, v127
    s_waitcnt vmcnt(0)
    s_barrier
    v_add_u32 v232, s26, v230
    v_add_u32 v233, s26, v231
    ds_read_b64_tr_b16 v[192:193], v232 offset:0
    ds_read_b64_tr_b16 v[194:195], v232 offset:3072
    ds_read_b64_tr_b16 v[196:197], v233 offset:64
    ds_read_b64_tr_b16 v[198:199], v233 offset:3136
    ds_read_b64_tr_b16 v[200:201], v232 offset:128
    ds_read_b64_tr_b16 v[202:203], v232 offset:3200
    ds_read_b64_tr_b16 v[204:205], v233 offset:192
    ds_read_b64_tr_b16 v[206:207], v233 offset:3264
    ds_read_b64_tr_b16 v[208:209], v232 offset:256
    ds_read_b64_tr_b16 v[210:211], v232 offset:3328
    s_waitcnt lgkmcnt(8)
    v_mfma_f32_32x32x16_bf16 v[0:15], v[192:195], v[176:179], v[0:15]
    ds_read_b64_tr_b16 v[212:213], v233 offset:320
    ds_read_b64_tr_b16 v[214:215], v233 offset:3392
    s_waitcnt lgkmcnt(8)
    v_mfma_f32_32x32x16_bf16 v[16:31], v[196:199], v[176:179], v[16:31]
    ds_read_b64_tr_b16 v[192:193], v232 offset:6144
    ds_read_b64_tr_b16 v[194:195], v232 offset:9216
    s_waitcnt lgkmcnt(8)
    v_mfma_f32_32x32x16_bf16 v[32:47], v[200:203], v[176:179], v[32:47]
    ds_read_b64_tr_b16 v[196:197], v233 offset:6208
    ds_read_b64_tr_b16 v[198:199], v233 offset:9280
    s_waitcnt lgkmcnt(8)
    v_mfma_f32_32x32x16_bf16 v[48:63], v[204:207], v[176:179], v[48:63]
    ds_read_b64_tr_b16 v[200:201], v232 offset:6272
    ds_read_b64_tr_b16 v[202:203], v232 offset:9344
    s_waitcnt lgkmcnt(8)
    v_mfma_f32_32x32x16_bf16 v[64:79], v[208:211], v[176:179], v[64:79]
    ds_read_b64_tr_b16 v[204:205], v233 offset:6336
    ds_read_b64_tr_b16 v[206:207], v233 offset:9408
    s_waitcnt lgkmcnt(8)
    v_mfma_f32_32x32x16_bf16 v[80:95], v[212:215], v[176:179], v[80:95]
    ds_read_b64_tr_b16 v[208:209], v232 offset:6400
    ds_read_b64_tr_b16 v[210:211], v232 offset:9472
    s_waitcnt lgkmcnt(8)
    v_mfma_f32_32x32x16_bf16 v[0:15], v[192:195], v[180:183], v[0:15]
    ds_read_b64_tr_b16 v[212:213], v233 offset:6464
    ds_read_b64_tr_b16 v[214:215], v233 offset:9536
    s_waitcnt lgkmcnt(8)
    v_mfma_f32_32x32x16_bf16 v[16:31], v[196:199], v[180:183], v[16:31]
    ds_read_b64_tr_b16 v[192:193], v232 offset:12288
    ds_read_b64_tr_b16 v[194:195], v232 offset:15360
    s_waitcnt lgkmcnt(8)
    v_mfma_f32_32x32x16_bf16 v[32:47], v[200:203], v[180:183], v[32:47]
    ds_read_b64_tr_b16 v[196:197], v233 offset:12352
    ds_read_b64_tr_b16 v[198:199], v233 offset:15424
    s_waitcnt lgkmcnt(8)
    v_mfma_f32_32x32x16_bf16 v[48:63], v[204:207], v[180:183], v[48:63]
    ds_read_b64_tr_b16 v[200:201], v232 offset:12416
    ds_read_b64_tr_b16 v[202:203], v232 offset:15488
    s_waitcnt lgkmcnt(8)
    v_mfma_f32_32x32x16_bf16 v[64:79], v[208:211], v[180:183], v[64:79]
    ds_read_b64_tr_b16 v[204:205], v233 offset:12480
    ds_read_b64_tr_b16 v[206:207], v233 offset:15552
    s_waitcnt lgkmcnt(8)
    v_mfma_f32_32x32x16_bf16 v[80:95], v[212:215], v[180:183], v[80:95]
    ds_read_b64_tr_b16 v[208:209], v232 offset:12544
    ds_read_b64_tr_b16 v[210:211], v232 offset:15616
    s_waitcnt lgkmcnt(8)
    v_mfma_f32_32x32x16_bf16 v[0:15], v[192:195], v[184:187], v[0:15]
    ds_read_b64_tr_b16 v[212:213], v233 offset:12608
    ds_read_b64_tr_b16 v[214:215], v233 offset:15680
    s_waitcnt lgkmcnt(8)
    v_mfma_f32_32x32x16_bf16 v[16:31], v[196:199], v[184:187], v[16:31]
    ds_read_b64_tr_b16 v[192:193], v232 offset:18432
    ds_read_b64_tr_b16 v[194:195], v232 offset:21504
    s_waitcnt lgkmcnt(8)
    v_mfma_f32_32x32x16_bf16 v[32:47], v[200:203], v[184:187], v[32:47]
    ds_read_b64_tr_b16 v[196:197], v233 offset:18496
    ds_read_b64_tr_b16 v[198:199], v233 offset:21568
    s_waitcnt lgkmcnt(8)
    v_mfma_f32_32x32x16_bf16 v[48:63], v[204:207], v[184:187], v[48:63]
    ds_read_b64_tr_b16 v[200:201], v232 offset:18560
    ds_read_b64_tr_b16 v[202:203], v232 offset:21632
    s_waitcnt lgkmcnt(8)
    v_mfma_f32_32x32x16_bf16 v[64:79], v[208:211], v[184:187], v[64:79]
    ds_read_b64_tr_b16 v[204:205], v233 offset:18624
    ds_read_b64_tr_b16 v[206:207], v233 offset:21696
    s_waitcnt lgkmcnt(8)
    v_mfma_f32_32x32x16_bf16 v[80:95], v[212:215], v[184:187], v[80:95]
    ds_read_b64_tr_b16 v[208:209], v232 offset:18688
    ds_read_b64_tr_b16 v[210:211], v232 offset:21760
    s_waitcnt lgkmcnt(8)
    v_mfma_f32_32x32x16_bf16 v[0:15], v[192:195], v[188:191], v[0:15]
    ds_read_b64_tr_b16 v[212:213], v233 offset:18752
    ds_read_b64_tr_b16 v[214:215], v233 offset:21824
    s_waitcnt lgkmcnt(8)
    v_mfma_f32_32x32x16_bf16 v[16:31], v[196:199], v[188:191], v[16:31]
    s_waitcnt lgkmcnt(6)
    v_mfma_f32_32x32x16_bf16 v[32:47], v[200:203], v[188:191], v[32:47]
    s_waitcnt lgkmcnt(4)
    v_mfma_f32_32x32x16_bf16 v[48:63], v[204:207], v[188:191], v[48:63]
    s_waitcnt lgkmcnt(2)
    v_mfma_f32_32x32x16_bf16 v[64:79], v[208:211], v[188:191], v[64:79]
    s_waitcnt lgkmcnt(0)
    v_mfma_f32_32x32x16_bf16 v[80:95], v[212:215], v[188:191], v[80:95]
    s_mov_b32 s52, s26
    s_mov_b32 s26, s27
    s_mov_b32 s27, s28
    s_mov_b32 s28, s52
    v_add_f32 v236, v236, v237
    v_add_f32 v238, v238, v239
    v_add_f32 v241, v236, v238
    v_mov_b32 v242, v241
    s_nop 1
    v_permlane32_swap_b32 v241, v242
    s_nop 1
    v_add_f32 v241, v241, v242
    v_rcp_f32 v240, v241
    s_nop 7
    v_mbcnt_lo_u32_b32 v254, -1, 0
    v_mbcnt_hi_u32_b32 v254, -1, v254
    v_lshlrev_b32 v254, 4, v254
    v_mul_f32 v0, v0, v240
    v_mul_f32 v1, v1, v240
    v_mul_f32 v2, v2, v240
    v_mul_f32 v3, v3, v240
    v_mul_f32 v4, v4, v240
    v_mul_f32 v5, v5, v240
    v_mul_f32 v6, v6, v240
    v_mul_f32 v7, v7, v240
    v_mul_f32 v8, v8, v240
    v_mul_f32 v9, v9, v240
    v_mul_f32 v10, v10, v240
    v_mul_f32 v11, v11, v240
    v_mul_f32 v12, v12, v240
    v_mul_f32 v13, v13, v240
    v_mul_f32 v14, v14, v240
    v_mul_f32 v15, v15, v240
    v_cvt_pk_bf16_f32 v128, v0, v1
    v_cvt_pk_bf16_f32 v129, v2, v3
    v_cvt_pk_bf16_f32 v130, v4, v5
    v_cvt_pk_bf16_f32 v131, v6, v7
    buffer_store_dwordx4 v[128:131], v254, s[20:23], 0 offen offset:0 sc1
    v_cvt_pk_bf16_f32 v132, v8, v9
    v_cvt_pk_bf16_f32 v133, v10, v11
    v_cvt_pk_bf16_f32 v134, v12, v13
    v_cvt_pk_bf16_f32 v135, v14, v15
    buffer_store_dwordx4 v[132:135], v254, s[20:23], 0 offen offset:1024 sc1
    v_mul_f32 v16, v16, v240
    v_mul_f32 v17, v17, v240
    v_mul_f32 v18, v18, v240
    v_mul_f32 v19, v19, v240
    v_mul_f32 v20, v20, v240
    v_mul_f32 v21, v21, v240
    v_mul_f32 v22, v22, v240
    v_mul_f32 v23, v23, v240
    v_mul_f32 v24, v24, v240
    v_mul_f32 v25, v25, v240
    v_mul_f32 v26, v26, v240
    v_mul_f32 v27, v27, v240
    v_mul_f32 v28, v28, v240
    v_mul_f32 v29, v29, v240
    v_mul_f32 v30, v30, v240
    v_mul_f32 v31, v31, v240
    v_cvt_pk_bf16_f32 v136, v16, v17
    v_cvt_pk_bf16_f32 v137, v18, v19
    v_cvt_pk_bf16_f32 v138, v20, v21
    v_cvt_pk_bf16_f32 v139, v22, v23
    buffer_store_dwordx4 v[136:139], v254, s[20:23], 0 offen offset:2048 sc1
    v_cvt_pk_bf16_f32 v140, v24, v25
    v_cvt_pk_bf16_f32 v141, v26, v27
    v_cvt_pk_bf16_f32 v142, v28, v29
    v_cvt_pk_bf16_f32 v143, v30, v31
    buffer_store_dwordx4 v[140:143], v254, s[20:23], 0 offen offset:3072 sc1
    v_mul_f32 v32, v32, v240
    v_mul_f32 v33, v33, v240
    v_mul_f32 v34, v34, v240
    v_mul_f32 v35, v35, v240
    v_mul_f32 v36, v36, v240
    v_mul_f32 v37, v37, v240
    v_mul_f32 v38, v38, v240
    v_mul_f32 v39, v39, v240
    v_mul_f32 v40, v40, v240
    v_mul_f32 v41, v41, v240
    v_mul_f32 v42, v42, v240
    v_mul_f32 v43, v43, v240
    v_mul_f32 v44, v44, v240
    v_mul_f32 v45, v45, v240
    v_mul_f32 v46, v46, v240
    v_mul_f32 v47, v47, v240
    v_cvt_pk_bf16_f32 v144, v32, v33
    v_cvt_pk_bf16_f32 v145, v34, v35
    v_cvt_pk_bf16_f32 v146, v36, v37
    v_cvt_pk_bf16_f32 v147, v38, v39
    s_mov_b32 s52, 4096
    buffer_store_dwordx4 v[144:147], v254, s[20:23], s52 offen offset:0 sc1
    v_cvt_pk_bf16_f32 v148, v40, v41
    v_cvt_pk_bf16_f32 v149, v42, v43
    v_cvt_pk_bf16_f32 v150, v44, v45
    v_cvt_pk_bf16_f32 v151, v46, v47
    s_mov_b32 s52, 4096
    buffer_store_dwordx4 v[148:151], v254, s[20:23], s52 offen offset:1024 sc1
    v_mul_f32 v48, v48, v240
    v_mul_f32 v49, v49, v240
    v_mul_f32 v50, v50, v240
    v_mul_f32 v51, v51, v240
    v_mul_f32 v52, v52, v240
    v_mul_f32 v53, v53, v240
    v_mul_f32 v54, v54, v240
    v_mul_f32 v55, v55, v240
    v_mul_f32 v56, v56, v240
    v_mul_f32 v57, v57, v240
    v_mul_f32 v58, v58, v240
    v_mul_f32 v59, v59, v240
    v_mul_f32 v60, v60, v240
    v_mul_f32 v61, v61, v240
    v_mul_f32 v62, v62, v240
    v_mul_f32 v63, v63, v240
    v_cvt_pk_bf16_f32 v152, v48, v49
    v_cvt_pk_bf16_f32 v153, v50, v51
    v_cvt_pk_bf16_f32 v154, v52, v53
    v_cvt_pk_bf16_f32 v155, v54, v55
    s_mov_b32 s52, 4096
    buffer_store_dwordx4 v[152:155], v254, s[20:23], s52 offen offset:2048 sc1
    v_cvt_pk_bf16_f32 v156, v56, v57
    v_cvt_pk_bf16_f32 v157, v58, v59
    v_cvt_pk_bf16_f32 v158, v60, v61
    v_cvt_pk_bf16_f32 v159, v62, v63
    s_mov_b32 s52, 4096
    buffer_store_dwordx4 v[156:159], v254, s[20:23], s52 offen offset:3072 sc1
    v_mul_f32 v64, v64, v240
    v_mul_f32 v65, v65, v240
    v_mul_f32 v66, v66, v240
    v_mul_f32 v67, v67, v240
    v_mul_f32 v68, v68, v240
    v_mul_f32 v69, v69, v240
    v_mul_f32 v70, v70, v240
    v_mul_f32 v71, v71, v240
    v_mul_f32 v72, v72, v240
    v_mul_f32 v73, v73, v240
    v_mul_f32 v74, v74, v240
    v_mul_f32 v75, v75, v240
    v_mul_f32 v76, v76, v240
    v_mul_f32 v77, v77, v240
    v_mul_f32 v78, v78, v240
    v_mul_f32 v79, v79, v240
    v_cvt_pk_bf16_f32 v160, v64, v65
    v_cvt_pk_bf16_f32 v161, v66, v67
    v_cvt_pk_bf16_f32 v162, v68, v69
    v_cvt_pk_bf16_f32 v163, v70, v71
    s_mov_b32 s52, 8192
    buffer_store_dwordx4 v[160:163], v254, s[20:23], s52 offen offset:0 sc1
    v_cvt_pk_bf16_f32 v164, v72, v73
    v_cvt_pk_bf16_f32 v165, v74, v75
    v_cvt_pk_bf16_f32 v166, v76, v77
    v_cvt_pk_bf16_f32 v167, v78, v79
    s_mov_b32 s52, 8192
    buffer_store_dwordx4 v[164:167], v254, s[20:23], s52 offen offset:1024 sc1
    v_mul_f32 v80, v80, v240
    v_mul_f32 v81, v81, v240
    v_mul_f32 v82, v82, v240
    v_mul_f32 v83, v83, v240
    v_mul_f32 v84, v84, v240
    v_mul_f32 v85, v85, v240
    v_mul_f32 v86, v86, v240
    v_mul_f32 v87, v87, v240
    v_mul_f32 v88, v88, v240
    v_mul_f32 v89, v89, v240
    v_mul_f32 v90, v90, v240
    v_mul_f32 v91, v91, v240
    v_mul_f32 v92, v92, v240
    v_mul_f32 v93, v93, v240
    v_mul_f32 v94, v94, v240
    v_mul_f32 v95, v95, v240
    v_cvt_pk_bf16_f32 v168, v80, v81
    v_cvt_pk_bf16_f32 v169, v82, v83
    v_cvt_pk_bf16_f32 v170, v84, v85
    v_cvt_pk_bf16_f32 v171, v86, v87
    s_mov_b32 s52, 8192
    buffer_store_dwordx4 v[168:171], v254, s[20:23], s52 offen offset:2048 sc1
    v_cvt_pk_bf16_f32 v172, v88, v89
    v_cvt_pk_bf16_f32 v173, v90, v91
    v_cvt_pk_bf16_f32 v174, v92, v93
    v_cvt_pk_bf16_f32 v175, v94, v95
    s_mov_b32 s52, 8192
    buffer_store_dwordx4 v[172:175], v254, s[20:23], s52 offen offset:3072 sc1
K1_END:
    s_endpgm
.globl mha_oproj_kernel
.p2align 8
.type mha_oproj_kernel,@function
mha_oproj_kernel:
    s_cmp_ge_u32 s2, 256
    s_cbranch_scc1 K2_END
    s_load_dwordx2 s[32:33], s[0:1], 32
    s_load_dwordx2 s[34:35], s[0:1], 72
    s_load_dwordx2 s[36:37], s[0:1], 96
    v_lshrrev_b32 v223, 6, v0
    v_and_b32 v224, 63, v0
    s_nop 0
    v_readfirstlane_b32 s24, v223
    s_lshr_b32 s25, s24, 2
    s_and_b32 s24, s24, 3
    s_and_b32 s42, s2, 7
    s_lshr_b32 s41, s2, 3
    s_and_b32 s44, s41, 3
    s_lshr_b32 s45, s41, 2
    s_and_b32 s45, s45, 3
    s_lshl_b32 s45, s45, 1
    s_add_u32 s45, s45, s25
    s_lshr_b32 s43, s41, 4
    s_and_b32 s43, s43, 1
    s_waitcnt lgkmcnt(0)
    s_cmp_eq_u32 s43, 0
    s_cselect_b64 s[32:33], s[32:33], s[34:35]
    s_mul_i32 s46, s42, 983040
    s_mul_i32 s47, s44, 320
    s_add_u32 s46, s46, s47
    s_add_u32 s32, s32, s46
    s_addc_u32 s33, s33, 0
    s_sub_u32 s47, 7864320, s46
    s_mov_b32 s4, s32
    s_and_b32 s5, s33, 0xffff
    s_mov_b32 s6, s47
    s_mov_b32 s7, 0x20000
    s_lshl_b32 s46, s43, 3
    s_add_u32 s46, s46, s45
    s_lshl_b32 s47, s46, 2
    s_add_u32 s47, s47, s24
    s_mul_i32 s47, s47, 393216
    s_mul_i32 s48, s42, 49152
    s_add_u32 s47, s47, s48
    s_mov_b64 s[38:39], s[36:37]
    s_add_u32 s38, s38, s47
    s_addc_u32 s39, s39, 0
    s_mov_b32 s8, s38
    s_and_b32 s9, s39, 0xffff
    s_mov_b32 s10, 49152
    s_mov_b32 s11, 0x20000
    s_lshl_b32 s46, s46, 2
    s_add_u32 s46, s46, s44
    s_lshl_b32 s46, s46, 2
    s_add_u32 s46, s46, s24
    s_mul_i32 s46, s46, 10240
    s_mul_i32 s47, s42, 2621440
    s_add_u32 s46, s46, s47
    s_add_u32 s46, s46, 25165824
    s_add_u32 s36, s36, s46
    s_addc_u32 s37, s37, 0
    s_mov_b32 s12, s36
    s_and_b32 s13, s37, 0xffff
    s_mov_b32 s14, 10240
    s_mov_b32 s15, 0x20000
    s_mul_i32 s28, s24, 5120
    s_mul_i32 s46, s25, 20480
    s_add_u32 s28, s28, s46
    s_mul_i32 s26, s28, 4
    s_mov_b32 s27, 0
    s_lshr_b32 s46, s45, 1
    s_add_u32 s46, s46, s44
    s_and_b32 s46, s46, 3
    s_lshr_b32 s46, s45, 1
    s_mul_i32 s47, s46, 163840
    s_add_u32 s26, s26, s47
    s_lshl_b32 s27, s46, 13
    v_mov_b32 v217, v224
    v_mul_u32_u24 v218, 3277, v217
    v_lshrrev_b32 v218, 16, v218
    v_mul_u32_u24 v219, 20, v218
    v_sub_u32 v219, v217, v219
    v_lshlrev_b32 v219, 4, v219
    v_mul_u32_u24 v218, 1280, v218
    v_add_u32 v208, v218, v219
    v_add_u32 v217, 64, v224
    v_mul_u32_u24 v218, 3277, v217
    v_lshrrev_b32 v218, 16, v218
    v_mul_u32_u24 v219, 20, v218
    v_sub_u32 v219, v217, v219
    v_lshlrev_b32 v219, 4, v219
    v_mul_u32_u24 v218, 1280, v218
    v_add_u32 v209, v218, v219
    v_add_u32 v217, 128, v224
    v_mul_u32_u24 v218, 3277, v217
    v_lshrrev_b32 v218, 16, v218
    v_mul_u32_u24 v219, 20, v218
    v_sub_u32 v219, v217, v219
    v_lshlrev_b32 v219, 4, v219
    v_mul_u32_u24 v218, 1280, v218
    v_add_u32 v210, v218, v219
    v_add_u32 v217, 192, v224
    v_mul_u32_u24 v218, 3277, v217
    v_lshrrev_b32 v218, 16, v218
    v_mul_u32_u24 v219, 20, v218
    v_sub_u32 v219, v217, v219
    v_lshlrev_b32 v219, 4, v219
    v_mul_u32_u24 v218, 1280, v218
    v_add_u32 v211, v218, v219
    v_add_u32 v217, 256, v224
    v_mul_u32_u24 v218, 3277, v217
    v_lshrrev_b32 v218, 16, v218
    v_mul_u32_u24 v219, 20, v218
    v_sub_u32 v219, v217, v219
    v_lshlrev_b32 v219, 4, v219
    v_mul_u32_u24 v218, 1280, v218
    v_add_u32 v212, v218, v219
    v_lshlrev_b32 v216, 4, v224
    s_add_u32 m0, s28, 0
    s_nop 0
    buffer_load_dwordx4 v208, s[4:7], s26 offen lds
    s_add_u32 m0, s28, 1024
    s_nop 0
    buffer_load_dwordx4 v209, s[4:7], s26 offen lds
    s_add_u32 m0, s28, 2048
    s_nop 0
    buffer_load_dwordx4 v210, s[4:7], s26 offen lds
    s_add_u32 m0, s28, 3072
    s_nop 0
    buffer_load_dwordx4 v211, s[4:7], s26 offen lds
    s_add_u32 m0, s28, 4096
    s_nop 0
    buffer_load_dwordx4 v212, s[4:7], s26 offen lds
    buffer_load_dwordx4 v[80:83], v216, s[8:11], s27 offen offset:0
    buffer_load_dwordx4 v[84:87], v216, s[8:11], s27 offen offset:1024
    buffer_load_dwordx4 v[88:91], v216, s[8:11], s27 offen offset:2048
    buffer_load_dwordx4 v[92:95], v216, s[8:11], s27 offen offset:3072
    s_add_u32 s29, s27, 4096
    buffer_load_dwordx4 v[96:99], v216, s[8:11], s29 offen offset:0
    buffer_load_dwordx4 v[100:103], v216, s[8:11], s29 offen offset:1024
    buffer_load_dwordx4 v[104:107], v216, s[8:11], s29 offen offset:2048
    buffer_load_dwordx4 v[108:111], v216, s[8:11], s29 offen offset:3072
    s_add_u32 s26, s26, 163840
    s_add_u32 s27, s27, 8192
    s_cmp_eq_u32 s27, 49152
    s_cselect_b32 s30, 983040, 0
    s_cselect_b32 s27, 0, s27
    s_sub_u32 s26, s26, s30
    v_lshrrev_b32 v217, 5, v224
    v_lshlrev_b32 v217, 2, v217
    v_bfe_u32 v218, v224, 2, 2
    v_add_u32 v217, v217, v218
    v_mul_u32_u24 v217, 320, v217
    v_bfe_u32 v218, v224, 4, 1
    v_lshlrev_b32 v218, 5, v218
    v_add_u32 v217, v217, v218
    v_and_b32 v218, 3, v224
    v_lshlrev_b32 v218, 3, v218
    v_add_u32 v213, v217, v218
    v_add_u32 v214, 40960, v213
    v_add_u32 v215, 81920, v213
    v_mov_b32 v0, 0
    v_mov_b32 v1, 0
    v_mov_b32 v2, 0
    v_mov_b32 v3, 0
    v_mov_b32 v4, 0
    v_mov_b32 v5, 0
    v_mov_b32 v6, 0
    v_mov_b32 v7, 0
    v_mov_b32 v8, 0
    v_mov_b32 v9, 0
    v_mov_b32 v10, 0
    v_mov_b32 v11, 0
    v_mov_b32 v12, 0
    v_mov_b32 v13, 0
    v_mov_b32 v14, 0
    v_mov_b32 v15, 0
    v_mov_b32 v16, 0
    v_mov_b32 v17, 0
    v_mov_b32 v18, 0
    v_mov_b32 v19, 0
    v_mov_b32 v20, 0
    v_mov_b32 v21, 0
    v_mov_b32 v22, 0
    v_mov_b32 v23, 0
    v_mov_b32 v24, 0
    v_mov_b32 v25, 0
    v_mov_b32 v26, 0
    v_mov_b32 v27, 0
    v_mov_b32 v28, 0
    v_mov_b32 v29, 0
    v_mov_b32 v30, 0
    v_mov_b32 v31, 0
    v_mov_b32 v32, 0
    v_mov_b32 v33, 0
    v_mov_b32 v34, 0
    v_mov_b32 v35, 0
    v_mov_b32 v36, 0
    v_mov_b32 v37, 0
    v_mov_b32 v38, 0
    v_mov_b32 v39, 0
    v_mov_b32 v40, 0
    v_mov_b32 v41, 0
    v_mov_b32 v42, 0
    v_mov_b32 v43, 0
    v_mov_b32 v44, 0
    v_mov_b32 v45, 0
    v_mov_b32 v46, 0
    v_mov_b32 v47, 0
    v_mov_b32 v48, 0
    v_mov_b32 v49, 0
    v_mov_b32 v50, 0
    v_mov_b32 v51, 0
    v_mov_b32 v52, 0
    v_mov_b32 v53, 0
    v_mov_b32 v54, 0
    v_mov_b32 v55, 0
    v_mov_b32 v56, 0
    v_mov_b32 v57, 0
    v_mov_b32 v58, 0
    v_mov_b32 v59, 0
    v_mov_b32 v60, 0
    v_mov_b32 v61, 0
    v_mov_b32 v62, 0
    v_mov_b32 v63, 0
    v_mov_b32 v64, 0
    v_mov_b32 v65, 0
    v_mov_b32 v66, 0
    v_mov_b32 v67, 0
    v_mov_b32 v68, 0
    v_mov_b32 v69, 0
    v_mov_b32 v70, 0
    v_mov_b32 v71, 0
    v_mov_b32 v72, 0
    v_mov_b32 v73, 0
    v_mov_b32 v74, 0
    v_mov_b32 v75, 0
    v_mov_b32 v76, 0
    v_mov_b32 v77, 0
    v_mov_b32 v78, 0
    v_mov_b32 v79, 0
    s_waitcnt vmcnt(0)
    s_barrier
    ds_read_b64_tr_b16 v[176:177], v213 offset:0
    ds_read_b64_tr_b16 v[178:179], v213 offset:2560
    ds_read_b64_tr_b16 v[180:181], v213 offset:64
    ds_read_b64_tr_b16 v[182:183], v213 offset:2624
    ds_read_b64_tr_b16 v[184:185], v213 offset:128
    ds_read_b64_tr_b16 v[186:187], v213 offset:2688
    ds_read_b64_tr_b16 v[188:189], v213 offset:192
    ds_read_b64_tr_b16 v[190:191], v213 offset:2752
    ds_read_b64_tr_b16 v[192:193], v213 offset:256
    ds_read_b64_tr_b16 v[194:195], v213 offset:2816
    ds_read_b64_tr_b16 v[196:197], v213 offset:5120
    ds_read_b64_tr_b16 v[198:199], v213 offset:7680
    s_waitcnt lgkmcnt(10)
    v_mfma_f32_32x32x16_bf16 v[0:15], v[176:179], v[80:83], v[0:15]
    ds_read_b64_tr_b16 v[200:201], v213 offset:5184
    ds_read_b64_tr_b16 v[202:203], v213 offset:7744
    s_add_u32 m0, s28, 40960
    s_nop 0
    buffer_load_dwordx4 v208, s[4:7], s26 offen lds
    s_waitcnt lgkmcnt(10)
    v_mfma_f32_32x32x16_bf16 v[16:31], v[180:183], v[80:83], v[16:31]
    ds_read_b64_tr_b16 v[204:205], v213 offset:5248
    ds_read_b64_tr_b16 v[206:207], v213 offset:7808
    s_add_u32 m0, s28, 41984
    s_nop 0
    buffer_load_dwordx4 v209, s[4:7], s26 offen lds
    s_waitcnt lgkmcnt(10)
    v_mfma_f32_32x32x16_bf16 v[32:47], v[184:187], v[80:83], v[32:47]
    ds_read_b64_tr_b16 v[176:177], v213 offset:5312
    ds_read_b64_tr_b16 v[178:179], v213 offset:7872
    s_add_u32 m0, s28, 43008
    s_nop 0
    buffer_load_dwordx4 v210, s[4:7], s26 offen lds
    s_waitcnt lgkmcnt(10)
    v_mfma_f32_32x32x16_bf16 v[48:63], v[188:191], v[80:83], v[48:63]
    ds_read_b64_tr_b16 v[180:181], v213 offset:5376
    ds_read_b64_tr_b16 v[182:183], v213 offset:7936
    s_add_u32 m0, s28, 44032
    s_nop 0
    buffer_load_dwordx4 v211, s[4:7], s26 offen lds
    s_waitcnt lgkmcnt(10)
    v_mfma_f32_32x32x16_bf16 v[64:79], v[192:195], v[80:83], v[64:79]
    ds_read_b64_tr_b16 v[184:185], v213 offset:10240
    ds_read_b64_tr_b16 v[186:187], v213 offset:12800
    s_add_u32 m0, s28, 45056
    s_nop 0
    buffer_load_dwordx4 v212, s[4:7], s26 offen lds
    s_waitcnt lgkmcnt(10)
    v_mfma_f32_32x32x16_bf16 v[0:15], v[196:199], v[84:87], v[0:15]
    ds_read_b64_tr_b16 v[188:189], v213 offset:10304
    ds_read_b64_tr_b16 v[190:191], v213 offset:12864
    buffer_load_dwordx4 v[112:115], v216, s[8:11], s27 offen offset:0
    s_waitcnt lgkmcnt(10)
    v_mfma_f32_32x32x16_bf16 v[16:31], v[200:203], v[84:87], v[16:31]
    ds_read_b64_tr_b16 v[192:193], v213 offset:10368
    ds_read_b64_tr_b16 v[194:195], v213 offset:12928
    buffer_load_dwordx4 v[116:119], v216, s[8:11], s27 offen offset:1024
    s_waitcnt lgkmcnt(10)
    v_mfma_f32_32x32x16_bf16 v[32:47], v[204:207], v[84:87], v[32:47]
    ds_read_b64_tr_b16 v[196:197], v213 offset:10432
    ds_read_b64_tr_b16 v[198:199], v213 offset:12992
    buffer_load_dwordx4 v[120:123], v216, s[8:11], s27 offen offset:2048
    s_waitcnt lgkmcnt(10)
    v_mfma_f32_32x32x16_bf16 v[48:63], v[176:179], v[84:87], v[48:63]
    ds_read_b64_tr_b16 v[200:201], v213 offset:10496
    ds_read_b64_tr_b16 v[202:203], v213 offset:13056
    buffer_load_dwordx4 v[124:127], v216, s[8:11], s27 offen offset:3072
    s_waitcnt lgkmcnt(10)
    v_mfma_f32_32x32x16_bf16 v[64:79], v[180:183], v[84:87], v[64:79]
    ds_read_b64_tr_b16 v[204:205], v213 offset:15360
    ds_read_b64_tr_b16 v[206:207], v213 offset:17920
    s_add_u32 s29, s27, 4096
    buffer_load_dwordx4 v[128:131], v216, s[8:11], s29 offen offset:0
    s_waitcnt lgkmcnt(10)
    v_mfma_f32_32x32x16_bf16 v[0:15], v[184:187], v[88:91], v[0:15]
    ds_read_b64_tr_b16 v[176:177], v213 offset:15424
    ds_read_b64_tr_b16 v[178:179], v213 offset:17984
    buffer_load_dwordx4 v[132:135], v216, s[8:11], s29 offen offset:1024
    s_waitcnt lgkmcnt(10)
    v_mfma_f32_32x32x16_bf16 v[16:31], v[188:191], v[88:91], v[16:31]
    ds_read_b64_tr_b16 v[180:181], v213 offset:15488
    ds_read_b64_tr_b16 v[182:183], v213 offset:18048
    buffer_load_dwordx4 v[136:139], v216, s[8:11], s29 offen offset:2048
    s_waitcnt lgkmcnt(10)
    v_mfma_f32_32x32x16_bf16 v[32:47], v[192:195], v[88:91], v[32:47]
    ds_read_b64_tr_b16 v[184:185], v213 offset:15552
    ds_read_b64_tr_b16 v[186:187], v213 offset:18112
    buffer_load_dwordx4 v[140:143], v216, s[8:11], s29 offen offset:3072
    s_add_u32 s26, s26, 163840
    s_add_u32 s27, s27, 8192
    s_cmp_eq_u32 s27, 49152
    s_cselect_b32 s30, 983040, 0
    s_cselect_b32 s27, 0, s27
    s_sub_u32 s26, s26, s30
    s_waitcnt lgkmcnt(10)
    v_mfma_f32_32x32x16_bf16 v[48:63], v[196:199], v[88:91], v[48:63]
    ds_read_b64_tr_b16 v[188:189], v213 offset:15616
    ds_read_b64_tr_b16 v[190:191], v213 offset:18176
    s_add_u32 m0, s28, 81920
    s_nop 0
    buffer_load_dwordx4 v208, s[4:7], s26 offen lds
    s_waitcnt lgkmcnt(10)
    v_mfma_f32_32x32x16_bf16 v[64:79], v[200:203], v[88:91], v[64:79]
    ds_read_b64_tr_b16 v[192:193], v213 offset:20480
    ds_read_b64_tr_b16 v[194:195], v213 offset:23040
    s_add_u32 m0, s28, 82944
    s_nop 0
    buffer_load_dwordx4 v209, s[4:7], s26 offen lds
    s_waitcnt lgkmcnt(10)
    v_mfma_f32_32x32x16_bf16 v[0:15], v[204:207], v[92:95], v[0:15]
    ds_read_b64_tr_b16 v[196:197], v213 offset:20544
    ds_read_b64_tr_b16 v[198:199], v213 offset:23104
    s_add_u32 m0, s28, 83968
    s_nop 0
    buffer_load_dwordx4 v210, s[4:7], s26 offen lds
    s_waitcnt lgkmcnt(10)
    v_mfma_f32_32x32x16_bf16 v[16:31], v[176:179], v[92:95], v[16:31]
    ds_read_b64_tr_b16 v[200:201], v213 offset:20608
    ds_read_b64_tr_b16 v[202:203], v213 offset:23168
    s_add_u32 m0, s28, 84992
    s_nop 0
    buffer_load_dwordx4 v211, s[4:7], s26 offen lds
    s_waitcnt lgkmcnt(10)
    v_mfma_f32_32x32x16_bf16 v[32:47], v[180:183], v[92:95], v[32:47]
    ds_read_b64_tr_b16 v[204:205], v213 offset:20672
    ds_read_b64_tr_b16 v[206:207], v213 offset:23232
    s_add_u32 m0, s28, 86016
    s_nop 0
    buffer_load_dwordx4 v212, s[4:7], s26 offen lds
    s_waitcnt lgkmcnt(10)
    v_mfma_f32_32x32x16_bf16 v[48:63], v[184:187], v[92:95], v[48:63]
    ds_read_b64_tr_b16 v[176:177], v213 offset:20736
    ds_read_b64_tr_b16 v[178:179], v213 offset:23296
    buffer_load_dwordx4 v[144:147], v216, s[8:11], s27 offen offset:0
    s_waitcnt lgkmcnt(10)
    v_mfma_f32_32x32x16_bf16 v[64:79], v[188:191], v[92:95], v[64:79]
    ds_read_b64_tr_b16 v[180:181], v213 offset:25600
    ds_read_b64_tr_b16 v[182:183], v213 offset:28160
    buffer_load_dwordx4 v[148:151], v216, s[8:11], s27 offen offset:1024
    s_waitcnt lgkmcnt(10)
    v_mfma_f32_32x32x16_bf16 v[0:15], v[192:195], v[96:99], v[0:15]
    ds_read_b64_tr_b16 v[184:185], v213 offset:25664
    ds_read_b64_tr_b16 v[186:187], v213 offset:28224
    buffer_load_dwordx4 v[152:155], v216, s[8:11], s27 offen offset:2048
    s_waitcnt lgkmcnt(10)
    v_mfma_f32_32x32x16_bf16 v[16:31], v[196:199], v[96:99], v[16:31]
    ds_read_b64_tr_b16 v[188:189], v213 offset:25728
    ds_read_b64_tr_b16 v[190:191], v213 offset:28288
    buffer_load_dwordx4 v[156:159], v216, s[8:11], s27 offen offset:3072
    s_waitcnt lgkmcnt(10)
    v_mfma_f32_32x32x16_bf16 v[32:47], v[200:203], v[96:99], v[32:47]
    ds_read_b64_tr_b16 v[192:193], v213 offset:25792
    ds_read_b64_tr_b16 v[194:195], v213 offset:28352
    s_add_u32 s29, s27, 4096
    buffer_load_dwordx4 v[160:163], v216, s[8:11], s29 offen offset:0
    s_waitcnt lgkmcnt(10)
    v_mfma_f32_32x32x16_bf16 v[48:63], v[204:207], v[96:99], v[48:63]
    ds_read_b64_tr_b16 v[196:197], v213 offset:25856
    ds_read_b64_tr_b16 v[198:199], v213 offset:28416
    buffer_load_dwordx4 v[164:167], v216, s[8:11], s29 offen offset:1024
    s_waitcnt lgkmcnt(10)
    v_mfma_f32_32x32x16_bf16 v[64:79], v[176:179], v[96:99], v[64:79]
    ds_read_b64_tr_b16 v[200:201], v213 offset:30720
    ds_read_b64_tr_b16 v[202:203], v213 offset:33280
    buffer_load_dwordx4 v[168:171], v216, s[8:11], s29 offen offset:2048
    s_waitcnt lgkmcnt(10)
    v_mfma_f32_32x32x16_bf16 v[0:15], v[180:183], v[100:103], v[0:15]
    ds_read_b64_tr_b16 v[204:205], v213 offset:30784
    ds_read_b64_tr_b16 v[206:207], v213 offset:33344
    buffer_load_dwordx4 v[172:175], v216, s[8:11], s29 offen offset:3072
    s_add_u32 s26, s26, 163840
    s_add_u32 s27, s27, 8192
    s_cmp_eq_u32 s27, 49152
    s_cselect_b32 s30, 983040, 0
    s_cselect_b32 s27, 0, s27
    s_sub_u32 s26, s26, s30
    s_waitcnt lgkmcnt(10)
    v_mfma_f32_32x32x16_bf16 v[16:31], v[184:187], v[100:103], v[16:31]
    ds_read_b64_tr_b16 v[176:177], v213 offset:30848
    ds_read_b64_tr_b16 v[178:179], v213 offset:33408
    s_waitcnt lgkmcnt(10)
    v_mfma_f32_32x32x16_bf16 v[32:47], v[188:191], v[100:103], v[32:47]
    ds_read_b64_tr_b16 v[180:181], v213 offset:30912
    ds_read_b64_tr_b16 v[182:183], v213 offset:33472
    s_waitcnt lgkmcnt(10)
    v_mfma_f32_32x32x16_bf16 v[48:63], v[192:195], v[100:103], v[48:63]
    ds_read_b64_tr_b16 v[184:185], v213 offset:30976
    ds_read_b64_tr_b16 v[186:187], v213 offset:33536
    s_waitcnt lgkmcnt(10)
    v_mfma_f32_32x32x16_bf16 v[64:79], v[196:199], v[100:103], v[64:79]
    ds_read_b64_tr_b16 v[188:189], v213 offset:35840
    ds_read_b64_tr_b16 v[190:191], v213 offset:38400
    s_waitcnt lgkmcnt(10)
    v_mfma_f32_32x32x16_bf16 v[0:15], v[200:203], v[104:107], v[0:15]
    ds_read_b64_tr_b16 v[192:193], v213 offset:35904
    ds_read_b64_tr_b16 v[194:195], v213 offset:38464
    s_waitcnt lgkmcnt(10)
    v_mfma_f32_32x32x16_bf16 v[16:31], v[204:207], v[104:107], v[16:31]
    ds_read_b64_tr_b16 v[196:197], v213 offset:35968
    ds_read_b64_tr_b16 v[198:199], v213 offset:38528
    s_waitcnt lgkmcnt(10)
    v_mfma_f32_32x32x16_bf16 v[32:47], v[176:179], v[104:107], v[32:47]
    ds_read_b64_tr_b16 v[200:201], v213 offset:36032
    ds_read_b64_tr_b16 v[202:203], v213 offset:38592
    s_waitcnt lgkmcnt(10)
    v_mfma_f32_32x32x16_bf16 v[48:63], v[180:183], v[104:107], v[48:63]
    ds_read_b64_tr_b16 v[204:205], v213 offset:36096
    ds_read_b64_tr_b16 v[206:207], v213 offset:38656
    s_waitcnt lgkmcnt(10)
    v_mfma_f32_32x32x16_bf16 v[64:79], v[184:187], v[104:107], v[64:79]
    s_waitcnt lgkmcnt(8)
    v_mfma_f32_32x32x16_bf16 v[0:15], v[188:191], v[108:111], v[0:15]
    s_waitcnt lgkmcnt(6)
    v_mfma_f32_32x32x16_bf16 v[16:31], v[192:195], v[108:111], v[16:31]
    s_waitcnt lgkmcnt(4)
    v_mfma_f32_32x32x16_bf16 v[32:47], v[196:199], v[108:111], v[32:47]
    s_waitcnt lgkmcnt(2)
    v_mfma_f32_32x32x16_bf16 v[48:63], v[200:203], v[108:111], v[48:63]
    s_waitcnt lgkmcnt(0)
    v_mfma_f32_32x32x16_bf16 v[64:79], v[204:207], v[108:111], v[64:79]
    s_waitcnt vmcnt(13)
    s_barrier
    ds_read_b64_tr_b16 v[176:177], v214 offset:0
    ds_read_b64_tr_b16 v[178:179], v214 offset:2560
    ds_read_b64_tr_b16 v[180:181], v214 offset:64
    ds_read_b64_tr_b16 v[182:183], v214 offset:2624
    ds_read_b64_tr_b16 v[184:185], v214 offset:128
    ds_read_b64_tr_b16 v[186:187], v214 offset:2688
    ds_read_b64_tr_b16 v[188:189], v214 offset:192
    ds_read_b64_tr_b16 v[190:191], v214 offset:2752
    ds_read_b64_tr_b16 v[192:193], v214 offset:256
    ds_read_b64_tr_b16 v[194:195], v214 offset:2816
    ds_read_b64_tr_b16 v[196:197], v214 offset:5120
    ds_read_b64_tr_b16 v[198:199], v214 offset:7680
    s_waitcnt lgkmcnt(10)
    v_mfma_f32_32x32x16_bf16 v[0:15], v[176:179], v[112:115], v[0:15]
    ds_read_b64_tr_b16 v[200:201], v214 offset:5184
    ds_read_b64_tr_b16 v[202:203], v214 offset:7744
    s_add_u32 m0, s28, 0
    s_nop 0
    buffer_load_dwordx4 v208, s[4:7], s26 offen lds
    s_waitcnt lgkmcnt(10)
    v_mfma_f32_32x32x16_bf16 v[16:31], v[180:183], v[112:115], v[16:31]
    ds_read_b64_tr_b16 v[204:205], v214 offset:5248
    ds_read_b64_tr_b16 v[206:207], v214 offset:7808
    s_waitcnt lgkmcnt(10)
    v_mfma_f32_32x32x16_bf16 v[32:47], v[184:187], v[112:115], v[32:47]
    ds_read_b64_tr_b16 v[176:177], v214 offset:5312
    ds_read_b64_tr_b16 v[178:179], v214 offset:7872
    s_waitcnt lgkmcnt(10)
    v_mfma_f32_32x32x16_bf16 v[48:63], v[188:191], v[112:115], v[48:63]
    ds_read_b64_tr_b16 v[180:181], v214 offset:5376
    ds_read_b64_tr_b16 v[182:183], v214 offset:7936
    s_add_u32 m0, s28, 1024
    s_nop 0
    buffer_load_dwordx4 v209, s[4:7], s26 offen lds
    s_waitcnt lgkmcnt(10)
    v_mfma_f32_32x32x16_bf16 v[64:79], v[192:195], v[112:115], v[64:79]
    ds_read_b64_tr_b16 v[184:185], v214 offset:10240
    ds_read_b64_tr_b16 v[186:187], v214 offset:12800
    s_waitcnt lgkmcnt(10)
    v_mfma_f32_32x32x16_bf16 v[0:15], v[196:199], v[116:119], v[0:15]
    ds_read_b64_tr_b16 v[188:189], v214 offset:10304
    ds_read_b64_tr_b16 v[190:191], v214 offset:12864
    s_waitcnt lgkmcnt(10)
    v_mfma_f32_32x32x16_bf16 v[16:31], v[200:203], v[116:119], v[16:31]
    ds_read_b64_tr_b16 v[192:193], v214 offset:10368
    ds_read_b64_tr_b16 v[194:195], v214 offset:12928
    s_add_u32 m0, s28, 2048
    s_nop 0
    buffer_load_dwordx4 v210, s[4:7], s26 offen lds
    s_waitcnt lgkmcnt(10)
    v_mfma_f32_32x32x16_bf16 v[32:47], v[204:207], v[116:119], v[32:47]
    ds_read_b64_tr_b16 v[196:197], v214 offset:10432
    ds_read_b64_tr_b16 v[198:199], v214 offset:12992
    s_waitcnt lgkmcnt(10)
    v_mfma_f32_32x32x16_bf16 v[48:63], v[176:179], v[116:119], v[48:63]
    ds_read_b64_tr_b16 v[200:201], v214 offset:10496
    ds_read_b64_tr_b16 v[202:203], v214 offset:13056
    s_waitcnt lgkmcnt(10)
    v_mfma_f32_32x32x16_bf16 v[64:79], v[180:183], v[116:119], v[64:79]
    ds_read_b64_tr_b16 v[204:205], v214 offset:15360
    ds_read_b64_tr_b16 v[206:207], v214 offset:17920
    s_add_u32 m0, s28, 3072
    s_nop 0
    buffer_load_dwordx4 v211, s[4:7], s26 offen lds
    s_waitcnt lgkmcnt(10)
    v_mfma_f32_32x32x16_bf16 v[0:15], v[184:187], v[120:123], v[0:15]
    ds_read_b64_tr_b16 v[176:177], v214 offset:15424
    ds_read_b64_tr_b16 v[178:179], v214 offset:17984
    s_waitcnt lgkmcnt(10)
    v_mfma_f32_32x32x16_bf16 v[16:31], v[188:191], v[120:123], v[16:31]
    ds_read_b64_tr_b16 v[180:181], v214 offset:15488
    ds_read_b64_tr_b16 v[182:183], v214 offset:18048
    s_waitcnt lgkmcnt(10)
    v_mfma_f32_32x32x16_bf16 v[32:47], v[192:195], v[120:123], v[32:47]
    ds_read_b64_tr_b16 v[184:185], v214 offset:15552
    ds_read_b64_tr_b16 v[186:187], v214 offset:18112
    s_add_u32 m0, s28, 4096
    s_nop 0
    buffer_load_dwordx4 v212, s[4:7], s26 offen lds
    s_waitcnt lgkmcnt(10)
    v_mfma_f32_32x32x16_bf16 v[48:63], v[196:199], v[120:123], v[48:63]
    ds_read_b64_tr_b16 v[188:189], v214 offset:15616
    ds_read_b64_tr_b16 v[190:191], v214 offset:18176
    s_waitcnt lgkmcnt(10)
    v_mfma_f32_32x32x16_bf16 v[64:79], v[200:203], v[120:123], v[64:79]
    ds_read_b64_tr_b16 v[192:193], v214 offset:20480
    ds_read_b64_tr_b16 v[194:195], v214 offset:23040
    s_waitcnt lgkmcnt(10)
    v_mfma_f32_32x32x16_bf16 v[0:15], v[204:207], v[124:127], v[0:15]
    ds_read_b64_tr_b16 v[196:197], v214 offset:20544
    ds_read_b64_tr_b16 v[198:199], v214 offset:23104
    buffer_load_dwordx4 v[80:83], v216, s[8:11], s27 offen offset:0
    s_waitcnt lgkmcnt(10)
    v_mfma_f32_32x32x16_bf16 v[16:31], v[176:179], v[124:127], v[16:31]
    ds_read_b64_tr_b16 v[200:201], v214 offset:20608
    ds_read_b64_tr_b16 v[202:203], v214 offset:23168
    s_waitcnt lgkmcnt(10)
    v_mfma_f32_32x32x16_bf16 v[32:47], v[180:183], v[124:127], v[32:47]
    ds_read_b64_tr_b16 v[204:205], v214 offset:20672
    ds_read_b64_tr_b16 v[206:207], v214 offset:23232
    s_waitcnt lgkmcnt(10)
    v_mfma_f32_32x32x16_bf16 v[48:63], v[184:187], v[124:127], v[48:63]
    ds_read_b64_tr_b16 v[176:177], v214 offset:20736
    ds_read_b64_tr_b16 v[178:179], v214 offset:23296
    buffer_load_dwordx4 v[84:87], v216, s[8:11], s27 offen offset:1024
    s_waitcnt lgkmcnt(10)
    v_mfma_f32_32x32x16_bf16 v[64:79], v[188:191], v[124:127], v[64:79]
    ds_read_b64_tr_b16 v[180:181], v214 offset:25600
    ds_read_b64_tr_b16 v[182:183], v214 offset:28160
    s_waitcnt lgkmcnt(10)
    v_mfma_f32_32x32x16_bf16 v[0:15], v[192:195], v[128:131], v[0:15]
    ds_read_b64_tr_b16 v[184:185], v214 offset:25664
    ds_read_b64_tr_b16 v[186:187], v214 offset:28224
    s_waitcnt lgkmcnt(10)
    v_mfma_f32_32x32x16_bf16 v[16:31], v[196:199], v[128:131], v[16:31]
    ds_read_b64_tr_b16 v[188:189], v214 offset:25728
    ds_read_b64_tr_b16 v[190:191], v214 offset:28288
    buffer_load_dwordx4 v[88:91], v216, s[8:11], s27 offen offset:2048
    s_waitcnt lgkmcnt(10)
    v_mfma_f32_32x32x16_bf16 v[32:47], v[200:203], v[128:131], v[32:47]
    ds_read_b64_tr_b16 v[192:193], v214 offset:25792
    ds_read_b64_tr_b16 v[194:195], v214 offset:28352
    s_waitcnt lgkmcnt(10)
    v_mfma_f32_32x32x16_bf16 v[48:63], v[204:207], v[128:131], v[48:63]
    ds_read_b64_tr_b16 v[196:197], v214 offset:25856
    ds_read_b64_tr_b16 v[198:199], v214 offset:28416
    s_waitcnt lgkmcnt(10)
    v_mfma_f32_32x32x16_bf16 v[64:79], v[176:179], v[128:131], v[64:79]
    ds_read_b64_tr_b16 v[200:201], v214 offset:30720
    ds_read_b64_tr_b16 v[202:203], v214 offset:33280
    buffer_load_dwordx4 v[92:95], v216, s[8:11], s27 offen offset:3072
    s_waitcnt lgkmcnt(10)
    v_mfma_f32_32x32x16_bf16 v[0:15], v[180:183], v[132:135], v[0:15]
    ds_read_b64_tr_b16 v[204:205], v214 offset:30784
    ds_read_b64_tr_b16 v[206:207], v214 offset:33344
    s_waitcnt lgkmcnt(10)
    v_mfma_f32_32x32x16_bf16 v[16:31], v[184:187], v[132:135], v[16:31]
    ds_read_b64_tr_b16 v[176:177], v214 offset:30848
    ds_read_b64_tr_b16 v[178:179], v214 offset:33408
    s_waitcnt lgkmcnt(10)
    v_mfma_f32_32x32x16_bf16 v[32:47], v[188:191], v[132:135], v[32:47]
    ds_read_b64_tr_b16 v[180:181], v214 offset:30912
    ds_read_b64_tr_b16 v[182:183], v214 offset:33472
    s_add_u32 s29, s27, 4096
    buffer_load_dwordx4 v[96:99], v216, s[8:11], s29 offen offset:0
    s_waitcnt lgkmcnt(10)
    v_mfma_f32_32x32x16_bf16 v[48:63], v[192:195], v[132:135], v[48:63]
    ds_read_b64_tr_b16 v[184:185], v214 offset:30976
    ds_read_b64_tr_b16 v[186:187], v214 offset:33536
    s_waitcnt lgkmcnt(10)
    v_mfma_f32_32x32x16_bf16 v[64:79], v[196:199], v[132:135], v[64:79]
    ds_read_b64_tr_b16 v[188:189], v214 offset:35840
    ds_read_b64_tr_b16 v[190:191], v214 offset:38400
    s_waitcnt lgkmcnt(10)
    v_mfma_f32_32x32x16_bf16 v[0:15], v[200:203], v[136:139], v[0:15]
    ds_read_b64_tr_b16 v[192:193], v214 offset:35904
    ds_read_b64_tr_b16 v[194:195], v214 offset:38464
    buffer_load_dwordx4 v[100:103], v216, s[8:11], s29 offen offset:1024
    s_waitcnt lgkmcnt(10)
    v_mfma_f32_32x32x16_bf16 v[16:31], v[204:207], v[136:139], v[16:31]
    ds_read_b64_tr_b16 v[196:197], v214 offset:35968
    ds_read_b64_tr_b16 v[198:199], v214 offset:38528
    s_waitcnt lgkmcnt(10)
    v_mfma_f32_32x32x16_bf16 v[32:47], v[176:179], v[136:139], v[32:47]
    ds_read_b64_tr_b16 v[200:201], v214 offset:36032
    ds_read_b64_tr_b16 v[202:203], v214 offset:38592
    s_waitcnt lgkmcnt(10)
    v_mfma_f32_32x32x16_bf16 v[48:63], v[180:183], v[136:139], v[48:63]
    ds_read_b64_tr_b16 v[204:205], v214 offset:36096
    ds_read_b64_tr_b16 v[206:207], v214 offset:38656
    buffer_load_dwordx4 v[104:107], v216, s[8:11], s29 offen offset:2048
    s_waitcnt lgkmcnt(10)
    v_mfma_f32_32x32x16_bf16 v[64:79], v[184:187], v[136:139], v[64:79]
    s_waitcnt lgkmcnt(8)
    v_mfma_f32_32x32x16_bf16 v[0:15], v[188:191], v[140:143], v[0:15]
    s_waitcnt lgkmcnt(6)
    v_mfma_f32_32x32x16_bf16 v[16:31], v[192:195], v[140:143], v[16:31]
    buffer_load_dwordx4 v[108:111], v216, s[8:11], s29 offen offset:3072
    s_add_u32 s26, s26, 163840
    s_add_u32 s27, s27, 8192
    s_cmp_eq_u32 s27, 49152
    s_cselect_b32 s30, 983040, 0
    s_cselect_b32 s27, 0, s27
    s_sub_u32 s26, s26, s30
    s_waitcnt lgkmcnt(4)
    v_mfma_f32_32x32x16_bf16 v[32:47], v[196:199], v[140:143], v[32:47]
    s_waitcnt lgkmcnt(2)
    v_mfma_f32_32x32x16_bf16 v[48:63], v[200:203], v[140:143], v[48:63]
    s_waitcnt lgkmcnt(0)
    v_mfma_f32_32x32x16_bf16 v[64:79], v[204:207], v[140:143], v[64:79]
    s_waitcnt vmcnt(13)
    s_barrier
    ds_read_b64_tr_b16 v[176:177], v215 offset:0
    ds_read_b64_tr_b16 v[178:179], v215 offset:2560
    ds_read_b64_tr_b16 v[180:181], v215 offset:64
    ds_read_b64_tr_b16 v[182:183], v215 offset:2624
    ds_read_b64_tr_b16 v[184:185], v215 offset:128
    ds_read_b64_tr_b16 v[186:187], v215 offset:2688
    ds_read_b64_tr_b16 v[188:189], v215 offset:192
    ds_read_b64_tr_b16 v[190:191], v215 offset:2752
    ds_read_b64_tr_b16 v[192:193], v215 offset:256
    ds_read_b64_tr_b16 v[194:195], v215 offset:2816
    ds_read_b64_tr_b16 v[196:197], v215 offset:5120
    ds_read_b64_tr_b16 v[198:199], v215 offset:7680
    s_waitcnt lgkmcnt(10)
    v_mfma_f32_32x32x16_bf16 v[0:15], v[176:179], v[144:147], v[0:15]
    ds_read_b64_tr_b16 v[200:201], v215 offset:5184
    ds_read_b64_tr_b16 v[202:203], v215 offset:7744
    s_add_u32 m0, s28, 40960
    s_nop 0
    buffer_load_dwordx4 v208, s[4:7], s26 offen lds
    s_waitcnt lgkmcnt(10)
    v_mfma_f32_32x32x16_bf16 v[16:31], v[180:183], v[144:147], v[16:31]
    ds_read_b64_tr_b16 v[204:205], v215 offset:5248
    ds_read_b64_tr_b16 v[206:207], v215 offset:7808
    s_waitcnt lgkmcnt(10)
    v_mfma_f32_32x32x16_bf16 v[32:47], v[184:187], v[144:147], v[32:47]
    ds_read_b64_tr_b16 v[176:177], v215 offset:5312
    ds_read_b64_tr_b16 v[178:179], v215 offset:7872
    s_waitcnt lgkmcnt(10)
    v_mfma_f32_32x32x16_bf16 v[48:63], v[188:191], v[144:147], v[48:63]
    ds_read_b64_tr_b16 v[180:181], v215 offset:5376
    ds_read_b64_tr_b16 v[182:183], v215 offset:7936
    s_add_u32 m0, s28, 41984
    s_nop 0
    buffer_load_dwordx4 v209, s[4:7], s26 offen lds
    s_waitcnt lgkmcnt(10)
    v_mfma_f32_32x32x16_bf16 v[64:79], v[192:195], v[144:147], v[64:79]
    ds_read_b64_tr_b16 v[184:185], v215 offset:10240
    ds_read_b64_tr_b16 v[186:187], v215 offset:12800
    s_waitcnt lgkmcnt(10)
    v_mfma_f32_32x32x16_bf16 v[0:15], v[196:199], v[148:151], v[0:15]
    ds_read_b64_tr_b16 v[188:189], v215 offset:10304
    ds_read_b64_tr_b16 v[190:191], v215 offset:12864
    s_waitcnt lgkmcnt(10)
    v_mfma_f32_32x32x16_bf16 v[16:31], v[200:203], v[148:151], v[16:31]
    ds_read_b64_tr_b16 v[192:193], v215 offset:10368
    ds_read_b64_tr_b16 v[194:195], v215 offset:12928
    s_add_u32 m0, s28, 43008
    s_nop 0
    buffer_load_dwordx4 v210, s[4:7], s26 offen lds
    s_waitcnt lgkmcnt(10)
    v_mfma_f32_32x32x16_bf16 v[32:47], v[204:207], v[148:151], v[32:47]
    ds_read_b64_tr_b16 v[196:197], v215 offset:10432
    ds_read_b64_tr_b16 v[198:199], v215 offset:12992
    s_waitcnt lgkmcnt(10)
    v_mfma_f32_32x32x16_bf16 v[48:63], v[176:179], v[148:151], v[48:63]
    ds_read_b64_tr_b16 v[200:201], v215 offset:10496
    ds_read_b64_tr_b16 v[202:203], v215 offset:13056
    s_waitcnt lgkmcnt(10)
    v_mfma_f32_32x32x16_bf16 v[64:79], v[180:183], v[148:151], v[64:79]
    ds_read_b64_tr_b16 v[204:205], v215 offset:15360
    ds_read_b64_tr_b16 v[206:207], v215 offset:17920
    s_add_u32 m0, s28, 44032
    s_nop 0
    buffer_load_dwordx4 v211, s[4:7], s26 offen lds
    s_waitcnt lgkmcnt(10)
    v_mfma_f32_32x32x16_bf16 v[0:15], v[184:187], v[152:155], v[0:15]
    ds_read_b64_tr_b16 v[176:177], v215 offset:15424
    ds_read_b64_tr_b16 v[178:179], v215 offset:17984
    s_waitcnt lgkmcnt(10)
    v_mfma_f32_32x32x16_bf16 v[16:31], v[188:191], v[152:155], v[16:31]
    ds_read_b64_tr_b16 v[180:181], v215 offset:15488
    ds_read_b64_tr_b16 v[182:183], v215 offset:18048
    s_waitcnt lgkmcnt(10)
    v_mfma_f32_32x32x16_bf16 v[32:47], v[192:195], v[152:155], v[32:47]
    ds_read_b64_tr_b16 v[184:185], v215 offset:15552
    ds_read_b64_tr_b16 v[186:187], v215 offset:18112
    s_add_u32 m0, s28, 45056
    s_nop 0
    buffer_load_dwordx4 v212, s[4:7], s26 offen lds
    s_waitcnt lgkmcnt(10)
    v_mfma_f32_32x32x16_bf16 v[48:63], v[196:199], v[152:155], v[48:63]
    ds_read_b64_tr_b16 v[188:189], v215 offset:15616
    ds_read_b64_tr_b16 v[190:191], v215 offset:18176
    s_waitcnt lgkmcnt(10)
    v_mfma_f32_32x32x16_bf16 v[64:79], v[200:203], v[152:155], v[64:79]
    ds_read_b64_tr_b16 v[192:193], v215 offset:20480
    ds_read_b64_tr_b16 v[194:195], v215 offset:23040
    s_waitcnt lgkmcnt(10)
    v_mfma_f32_32x32x16_bf16 v[0:15], v[204:207], v[156:159], v[0:15]
    ds_read_b64_tr_b16 v[196:197], v215 offset:20544
    ds_read_b64_tr_b16 v[198:199], v215 offset:23104
    buffer_load_dwordx4 v[112:115], v216, s[8:11], s27 offen offset:0
    s_waitcnt lgkmcnt(10)
    v_mfma_f32_32x32x16_bf16 v[16:31], v[176:179], v[156:159], v[16:31]
    ds_read_b64_tr_b16 v[200:201], v215 offset:20608
    ds_read_b64_tr_b16 v[202:203], v215 offset:23168
    s_waitcnt lgkmcnt(10)
    v_mfma_f32_32x32x16_bf16 v[32:47], v[180:183], v[156:159], v[32:47]
    ds_read_b64_tr_b16 v[204:205], v215 offset:20672
    ds_read_b64_tr_b16 v[206:207], v215 offset:23232
    s_waitcnt lgkmcnt(10)
    v_mfma_f32_32x32x16_bf16 v[48:63], v[184:187], v[156:159], v[48:63]
    ds_read_b64_tr_b16 v[176:177], v215 offset:20736
    ds_read_b64_tr_b16 v[178:179], v215 offset:23296
    buffer_load_dwordx4 v[116:119], v216, s[8:11], s27 offen offset:1024
    s_waitcnt lgkmcnt(10)
    v_mfma_f32_32x32x16_bf16 v[64:79], v[188:191], v[156:159], v[64:79]
    ds_read_b64_tr_b16 v[180:181], v215 offset:25600
    ds_read_b64_tr_b16 v[182:183], v215 offset:28160
    s_waitcnt lgkmcnt(10)
    v_mfma_f32_32x32x16_bf16 v[0:15], v[192:195], v[160:163], v[0:15]
    ds_read_b64_tr_b16 v[184:185], v215 offset:25664
    ds_read_b64_tr_b16 v[186:187], v215 offset:28224
    s_waitcnt lgkmcnt(10)
    v_mfma_f32_32x32x16_bf16 v[16:31], v[196:199], v[160:163], v[16:31]
    ds_read_b64_tr_b16 v[188:189], v215 offset:25728
    ds_read_b64_tr_b16 v[190:191], v215 offset:28288
    buffer_load_dwordx4 v[120:123], v216, s[8:11], s27 offen offset:2048
    s_waitcnt lgkmcnt(10)
    v_mfma_f32_32x32x16_bf16 v[32:47], v[200:203], v[160:163], v[32:47]
    ds_read_b64_tr_b16 v[192:193], v215 offset:25792
    ds_read_b64_tr_b16 v[194:195], v215 offset:28352
    s_waitcnt lgkmcnt(10)
    v_mfma_f32_32x32x16_bf16 v[48:63], v[204:207], v[160:163], v[48:63]
    ds_read_b64_tr_b16 v[196:197], v215 offset:25856
    ds_read_b64_tr_b16 v[198:199], v215 offset:28416
    s_waitcnt lgkmcnt(10)
    v_mfma_f32_32x32x16_bf16 v[64:79], v[176:179], v[160:163], v[64:79]
    ds_read_b64_tr_b16 v[200:201], v215 offset:30720
    ds_read_b64_tr_b16 v[202:203], v215 offset:33280
    buffer_load_dwordx4 v[124:127], v216, s[8:11], s27 offen offset:3072
    s_waitcnt lgkmcnt(10)
    v_mfma_f32_32x32x16_bf16 v[0:15], v[180:183], v[164:167], v[0:15]
    ds_read_b64_tr_b16 v[204:205], v215 offset:30784
    ds_read_b64_tr_b16 v[206:207], v215 offset:33344
    s_waitcnt lgkmcnt(10)
    v_mfma_f32_32x32x16_bf16 v[16:31], v[184:187], v[164:167], v[16:31]
    ds_read_b64_tr_b16 v[176:177], v215 offset:30848
    ds_read_b64_tr_b16 v[178:179], v215 offset:33408
    s_waitcnt lgkmcnt(10)
    v_mfma_f32_32x32x16_bf16 v[32:47], v[188:191], v[164:167], v[32:47]
    ds_read_b64_tr_b16 v[180:181], v215 offset:30912
    ds_read_b64_tr_b16 v[182:183], v215 offset:33472
    s_add_u32 s29, s27, 4096
    buffer_load_dwordx4 v[128:131], v216, s[8:11], s29 offen offset:0
    s_waitcnt lgkmcnt(10)
    v_mfma_f32_32x32x16_bf16 v[48:63], v[192:195], v[164:167], v[48:63]
    ds_read_b64_tr_b16 v[184:185], v215 offset:30976
    ds_read_b64_tr_b16 v[186:187], v215 offset:33536
    s_waitcnt lgkmcnt(10)
    v_mfma_f32_32x32x16_bf16 v[64:79], v[196:199], v[164:167], v[64:79]
    ds_read_b64_tr_b16 v[188:189], v215 offset:35840
    ds_read_b64_tr_b16 v[190:191], v215 offset:38400
    s_waitcnt lgkmcnt(10)
    v_mfma_f32_32x32x16_bf16 v[0:15], v[200:203], v[168:171], v[0:15]
    ds_read_b64_tr_b16 v[192:193], v215 offset:35904
    ds_read_b64_tr_b16 v[194:195], v215 offset:38464
    buffer_load_dwordx4 v[132:135], v216, s[8:11], s29 offen offset:1024
    s_waitcnt lgkmcnt(10)
    v_mfma_f32_32x32x16_bf16 v[16:31], v[204:207], v[168:171], v[16:31]
    ds_read_b64_tr_b16 v[196:197], v215 offset:35968
    ds_read_b64_tr_b16 v[198:199], v215 offset:38528
    s_waitcnt lgkmcnt(10)
    v_mfma_f32_32x32x16_bf16 v[32:47], v[176:179], v[168:171], v[32:47]
    ds_read_b64_tr_b16 v[200:201], v215 offset:36032
    ds_read_b64_tr_b16 v[202:203], v215 offset:38592
    s_waitcnt lgkmcnt(10)
    v_mfma_f32_32x32x16_bf16 v[48:63], v[180:183], v[168:171], v[48:63]
    ds_read_b64_tr_b16 v[204:205], v215 offset:36096
    ds_read_b64_tr_b16 v[206:207], v215 offset:38656
    buffer_load_dwordx4 v[136:139], v216, s[8:11], s29 offen offset:2048
    s_waitcnt lgkmcnt(10)
    v_mfma_f32_32x32x16_bf16 v[64:79], v[184:187], v[168:171], v[64:79]
    s_waitcnt lgkmcnt(8)
    v_mfma_f32_32x32x16_bf16 v[0:15], v[188:191], v[172:175], v[0:15]
    s_waitcnt lgkmcnt(6)
    v_mfma_f32_32x32x16_bf16 v[16:31], v[192:195], v[172:175], v[16:31]
    buffer_load_dwordx4 v[140:143], v216, s[8:11], s29 offen offset:3072
    s_add_u32 s26, s26, 163840
    s_add_u32 s27, s27, 8192
    s_cmp_eq_u32 s27, 49152
    s_cselect_b32 s30, 983040, 0
    s_cselect_b32 s27, 0, s27
    s_sub_u32 s26, s26, s30
    s_waitcnt lgkmcnt(4)
    v_mfma_f32_32x32x16_bf16 v[32:47], v[196:199], v[172:175], v[32:47]
    s_waitcnt lgkmcnt(2)
    v_mfma_f32_32x32x16_bf16 v[48:63], v[200:203], v[172:175], v[48:63]
    s_waitcnt lgkmcnt(0)
    v_mfma_f32_32x32x16_bf16 v[64:79], v[204:207], v[172:175], v[64:79]
    s_waitcnt vmcnt(13)
    s_barrier
    ds_read_b64_tr_b16 v[176:177], v213 offset:0
    ds_read_b64_tr_b16 v[178:179], v213 offset:2560
    ds_read_b64_tr_b16 v[180:181], v213 offset:64
    ds_read_b64_tr_b16 v[182:183], v213 offset:2624
    ds_read_b64_tr_b16 v[184:185], v213 offset:128
    ds_read_b64_tr_b16 v[186:187], v213 offset:2688
    ds_read_b64_tr_b16 v[188:189], v213 offset:192
    ds_read_b64_tr_b16 v[190:191], v213 offset:2752
    ds_read_b64_tr_b16 v[192:193], v213 offset:256
    ds_read_b64_tr_b16 v[194:195], v213 offset:2816
    ds_read_b64_tr_b16 v[196:197], v213 offset:5120
    ds_read_b64_tr_b16 v[198:199], v213 offset:7680
    s_waitcnt lgkmcnt(10)
    v_mfma_f32_32x32x16_bf16 v[0:15], v[176:179], v[80:83], v[0:15]
    ds_read_b64_tr_b16 v[200:201], v213 offset:5184
    ds_read_b64_tr_b16 v[202:203], v213 offset:7744
    s_add_u32 m0, s28, 81920
    s_nop 0
    buffer_load_dwordx4 v208, s[4:7], s26 offen lds
    s_waitcnt lgkmcnt(10)
    v_mfma_f32_32x32x16_bf16 v[16:31], v[180:183], v[80:83], v[16:31]
    ds_read_b64_tr_b16 v[204:205], v213 offset:5248
    ds_read_b64_tr_b16 v[206:207], v213 offset:7808
    s_waitcnt lgkmcnt(10)
    v_mfma_f32_32x32x16_bf16 v[32:47], v[184:187], v[80:83], v[32:47]
    ds_read_b64_tr_b16 v[176:177], v213 offset:5312
    ds_read_b64_tr_b16 v[178:179], v213 offset:7872
    s_waitcnt lgkmcnt(10)
    v_mfma_f32_32x32x16_bf16 v[48:63], v[188:191], v[80:83], v[48:63]
    ds_read_b64_tr_b16 v[180:181], v213 offset:5376
    ds_read_b64_tr_b16 v[182:183], v213 offset:7936
    s_add_u32 m0, s28, 82944
    s_nop 0
    buffer_load_dwordx4 v209, s[4:7], s26 offen lds
    s_waitcnt lgkmcnt(10)
    v_mfma_f32_32x32x16_bf16 v[64:79], v[192:195], v[80:83], v[64:79]
    ds_read_b64_tr_b16 v[184:185], v213 offset:10240
    ds_read_b64_tr_b16 v[186:187], v213 offset:12800
    s_waitcnt lgkmcnt(10)
    v_mfma_f32_32x32x16_bf16 v[0:15], v[196:199], v[84:87], v[0:15]
    ds_read_b64_tr_b16 v[188:189], v213 offset:10304
    ds_read_b64_tr_b16 v[190:191], v213 offset:12864
    s_waitcnt lgkmcnt(10)
    v_mfma_f32_32x32x16_bf16 v[16:31], v[200:203], v[84:87], v[16:31]
    ds_read_b64_tr_b16 v[192:193], v213 offset:10368
    ds_read_b64_tr_b16 v[194:195], v213 offset:12928
    s_add_u32 m0, s28, 83968
    s_nop 0
    buffer_load_dwordx4 v210, s[4:7], s26 offen lds
    s_waitcnt lgkmcnt(10)
    v_mfma_f32_32x32x16_bf16 v[32:47], v[204:207], v[84:87], v[32:47]
    ds_read_b64_tr_b16 v[196:197], v213 offset:10432
    ds_read_b64_tr_b16 v[198:199], v213 offset:12992
    s_waitcnt lgkmcnt(10)
    v_mfma_f32_32x32x16_bf16 v[48:63], v[176:179], v[84:87], v[48:63]
    ds_read_b64_tr_b16 v[200:201], v213 offset:10496
    ds_read_b64_tr_b16 v[202:203], v213 offset:13056
    s_waitcnt lgkmcnt(10)
    v_mfma_f32_32x32x16_bf16 v[64:79], v[180:183], v[84:87], v[64:79]
    ds_read_b64_tr_b16 v[204:205], v213 offset:15360
    ds_read_b64_tr_b16 v[206:207], v213 offset:17920
    s_add_u32 m0, s28, 84992
    s_nop 0
    buffer_load_dwordx4 v211, s[4:7], s26 offen lds
    s_waitcnt lgkmcnt(10)
    v_mfma_f32_32x32x16_bf16 v[0:15], v[184:187], v[88:91], v[0:15]
    ds_read_b64_tr_b16 v[176:177], v213 offset:15424
    ds_read_b64_tr_b16 v[178:179], v213 offset:17984
    s_waitcnt lgkmcnt(10)
    v_mfma_f32_32x32x16_bf16 v[16:31], v[188:191], v[88:91], v[16:31]
    ds_read_b64_tr_b16 v[180:181], v213 offset:15488
    ds_read_b64_tr_b16 v[182:183], v213 offset:18048
    s_waitcnt lgkmcnt(10)
    v_mfma_f32_32x32x16_bf16 v[32:47], v[192:195], v[88:91], v[32:47]
    ds_read_b64_tr_b16 v[184:185], v213 offset:15552
    ds_read_b64_tr_b16 v[186:187], v213 offset:18112
    s_add_u32 m0, s28, 86016
    s_nop 0
    buffer_load_dwordx4 v212, s[4:7], s26 offen lds
    s_waitcnt lgkmcnt(10)
    v_mfma_f32_32x32x16_bf16 v[48:63], v[196:199], v[88:91], v[48:63]
    ds_read_b64_tr_b16 v[188:189], v213 offset:15616
    ds_read_b64_tr_b16 v[190:191], v213 offset:18176
    s_waitcnt lgkmcnt(10)
    v_mfma_f32_32x32x16_bf16 v[64:79], v[200:203], v[88:91], v[64:79]
    ds_read_b64_tr_b16 v[192:193], v213 offset:20480
    ds_read_b64_tr_b16 v[194:195], v213 offset:23040
    s_waitcnt lgkmcnt(10)
    v_mfma_f32_32x32x16_bf16 v[0:15], v[204:207], v[92:95], v[0:15]
    ds_read_b64_tr_b16 v[196:197], v213 offset:20544
    ds_read_b64_tr_b16 v[198:199], v213 offset:23104
    buffer_load_dwordx4 v[144:147], v216, s[8:11], s27 offen offset:0
    s_waitcnt lgkmcnt(10)
    v_mfma_f32_32x32x16_bf16 v[16:31], v[176:179], v[92:95], v[16:31]
    ds_read_b64_tr_b16 v[200:201], v213 offset:20608
    ds_read_b64_tr_b16 v[202:203], v213 offset:23168
    s_waitcnt lgkmcnt(10)
    v_mfma_f32_32x32x16_bf16 v[32:47], v[180:183], v[92:95], v[32:47]
    ds_read_b64_tr_b16 v[204:205], v213 offset:20672
    ds_read_b64_tr_b16 v[206:207], v213 offset:23232
    s_waitcnt lgkmcnt(10)
    v_mfma_f32_32x32x16_bf16 v[48:63], v[184:187], v[92:95], v[48:63]
    ds_read_b64_tr_b16 v[176:177], v213 offset:20736
    ds_read_b64_tr_b16 v[178:179], v213 offset:23296
    buffer_load_dwordx4 v[148:151], v216, s[8:11], s27 offen offset:1024
    s_waitcnt lgkmcnt(10)
    v_mfma_f32_32x32x16_bf16 v[64:79], v[188:191], v[92:95], v[64:79]
    ds_read_b64_tr_b16 v[180:181], v213 offset:25600
    ds_read_b64_tr_b16 v[182:183], v213 offset:28160
    s_waitcnt lgkmcnt(10)
    v_mfma_f32_32x32x16_bf16 v[0:15], v[192:195], v[96:99], v[0:15]
    ds_read_b64_tr_b16 v[184:185], v213 offset:25664
    ds_read_b64_tr_b16 v[186:187], v213 offset:28224
    s_waitcnt lgkmcnt(10)
    v_mfma_f32_32x32x16_bf16 v[16:31], v[196:199], v[96:99], v[16:31]
    ds_read_b64_tr_b16 v[188:189], v213 offset:25728
    ds_read_b64_tr_b16 v[190:191], v213 offset:28288
    buffer_load_dwordx4 v[152:155], v216, s[8:11], s27 offen offset:2048
    s_waitcnt lgkmcnt(10)
    v_mfma_f32_32x32x16_bf16 v[32:47], v[200:203], v[96:99], v[32:47]
    ds_read_b64_tr_b16 v[192:193], v213 offset:25792
    ds_read_b64_tr_b16 v[194:195], v213 offset:28352
    s_waitcnt lgkmcnt(10)
    v_mfma_f32_32x32x16_bf16 v[48:63], v[204:207], v[96:99], v[48:63]
    ds_read_b64_tr_b16 v[196:197], v213 offset:25856
    ds_read_b64_tr_b16 v[198:199], v213 offset:28416
    s_waitcnt lgkmcnt(10)
    v_mfma_f32_32x32x16_bf16 v[64:79], v[176:179], v[96:99], v[64:79]
    ds_read_b64_tr_b16 v[200:201], v213 offset:30720
    ds_read_b64_tr_b16 v[202:203], v213 offset:33280
    buffer_load_dwordx4 v[156:159], v216, s[8:11], s27 offen offset:3072
    s_waitcnt lgkmcnt(10)
    v_mfma_f32_32x32x16_bf16 v[0:15], v[180:183], v[100:103], v[0:15]
    ds_read_b64_tr_b16 v[204:205], v213 offset:30784
    ds_read_b64_tr_b16 v[206:207], v213 offset:33344
    s_waitcnt lgkmcnt(10)
    v_mfma_f32_32x32x16_bf16 v[16:31], v[184:187], v[100:103], v[16:31]
    ds_read_b64_tr_b16 v[176:177], v213 offset:30848
    ds_read_b64_tr_b16 v[178:179], v213 offset:33408
    s_waitcnt lgkmcnt(10)
    v_mfma_f32_32x32x16_bf16 v[32:47], v[188:191], v[100:103], v[32:47]
    ds_read_b64_tr_b16 v[180:181], v213 offset:30912
    ds_read_b64_tr_b16 v[182:183], v213 offset:33472
    s_add_u32 s29, s27, 4096
    buffer_load_dwordx4 v[160:163], v216, s[8:11], s29 offen offset:0
    s_waitcnt lgkmcnt(10)
    v_mfma_f32_32x32x16_bf16 v[48:63], v[192:195], v[100:103], v[48:63]
    ds_read_b64_tr_b16 v[184:185], v213 offset:30976
    ds_read_b64_tr_b16 v[186:187], v213 offset:33536
    s_waitcnt lgkmcnt(10)
    v_mfma_f32_32x32x16_bf16 v[64:79], v[196:199], v[100:103], v[64:79]
    ds_read_b64_tr_b16 v[188:189], v213 offset:35840
    ds_read_b64_tr_b16 v[190:191], v213 offset:38400
    s_waitcnt lgkmcnt(10)
    v_mfma_f32_32x32x16_bf16 v[0:15], v[200:203], v[104:107], v[0:15]
    ds_read_b64_tr_b16 v[192:193], v213 offset:35904
    ds_read_b64_tr_b16 v[194:195], v213 offset:38464
    buffer_load_dwordx4 v[164:167], v216, s[8:11], s29 offen offset:1024
    s_waitcnt lgkmcnt(10)
    v_mfma_f32_32x32x16_bf16 v[16:31], v[204:207], v[104:107], v[16:31]
    ds_read_b64_tr_b16 v[196:197], v213 offset:35968
    ds_read_b64_tr_b16 v[198:199], v213 offset:38528
    s_waitcnt lgkmcnt(10)
    v_mfma_f32_32x32x16_bf16 v[32:47], v[176:179], v[104:107], v[32:47]
    ds_read_b64_tr_b16 v[200:201], v213 offset:36032
    ds_read_b64_tr_b16 v[202:203], v213 offset:38592
    s_waitcnt lgkmcnt(10)
    v_mfma_f32_32x32x16_bf16 v[48:63], v[180:183], v[104:107], v[48:63]
    ds_read_b64_tr_b16 v[204:205], v213 offset:36096
    ds_read_b64_tr_b16 v[206:207], v213 offset:38656
    buffer_load_dwordx4 v[168:171], v216, s[8:11], s29 offen offset:2048
    s_waitcnt lgkmcnt(10)
    v_mfma_f32_32x32x16_bf16 v[64:79], v[184:187], v[104:107], v[64:79]
    s_waitcnt lgkmcnt(8)
    v_mfma_f32_32x32x16_bf16 v[0:15], v[188:191], v[108:111], v[0:15]
    s_waitcnt lgkmcnt(6)
    v_mfma_f32_32x32x16_bf16 v[16:31], v[192:195], v[108:111], v[16:31]
    buffer_load_dwordx4 v[172:175], v216, s[8:11], s29 offen offset:3072
    s_add_u32 s26, s26, 163840
    s_add_u32 s27, s27, 8192
    s_cmp_eq_u32 s27, 49152
    s_cselect_b32 s30, 983040, 0
    s_cselect_b32 s27, 0, s27
    s_sub_u32 s26, s26, s30
    s_waitcnt lgkmcnt(4)
    v_mfma_f32_32x32x16_bf16 v[32:47], v[196:199], v[108:111], v[32:47]
    s_waitcnt lgkmcnt(2)
    v_mfma_f32_32x32x16_bf16 v[48:63], v[200:203], v[108:111], v[48:63]
    s_waitcnt lgkmcnt(0)
    v_mfma_f32_32x32x16_bf16 v[64:79], v[204:207], v[108:111], v[64:79]
    s_waitcnt vmcnt(13)
    s_barrier
    ds_read_b64_tr_b16 v[176:177], v214 offset:0
    ds_read_b64_tr_b16 v[178:179], v214 offset:2560
    ds_read_b64_tr_b16 v[180:181], v214 offset:64
    ds_read_b64_tr_b16 v[182:183], v214 offset:2624
    ds_read_b64_tr_b16 v[184:185], v214 offset:128
    ds_read_b64_tr_b16 v[186:187], v214 offset:2688
    ds_read_b64_tr_b16 v[188:189], v214 offset:192
    ds_read_b64_tr_b16 v[190:191], v214 offset:2752
    ds_read_b64_tr_b16 v[192:193], v214 offset:256
    ds_read_b64_tr_b16 v[194:195], v214 offset:2816
    ds_read_b64_tr_b16 v[196:197], v214 offset:5120
    ds_read_b64_tr_b16 v[198:199], v214 offset:7680
    s_waitcnt lgkmcnt(10)
    v_mfma_f32_32x32x16_bf16 v[0:15], v[176:179], v[112:115], v[0:15]
    ds_read_b64_tr_b16 v[200:201], v214 offset:5184
    ds_read_b64_tr_b16 v[202:203], v214 offset:7744
    s_waitcnt lgkmcnt(10)
    v_mfma_f32_32x32x16_bf16 v[16:31], v[180:183], v[112:115], v[16:31]
    ds_read_b64_tr_b16 v[204:205], v214 offset:5248
    ds_read_b64_tr_b16 v[206:207], v214 offset:7808
    s_waitcnt lgkmcnt(10)
    v_mfma_f32_32x32x16_bf16 v[32:47], v[184:187], v[112:115], v[32:47]
    ds_read_b64_tr_b16 v[176:177], v214 offset:5312
    ds_read_b64_tr_b16 v[178:179], v214 offset:7872
    s_waitcnt lgkmcnt(10)
    v_mfma_f32_32x32x16_bf16 v[48:63], v[188:191], v[112:115], v[48:63]
    ds_read_b64_tr_b16 v[180:181], v214 offset:5376
    ds_read_b64_tr_b16 v[182:183], v214 offset:7936
    s_waitcnt lgkmcnt(10)
    v_mfma_f32_32x32x16_bf16 v[64:79], v[192:195], v[112:115], v[64:79]
    ds_read_b64_tr_b16 v[184:185], v214 offset:10240
    ds_read_b64_tr_b16 v[186:187], v214 offset:12800
    s_waitcnt lgkmcnt(10)
    v_mfma_f32_32x32x16_bf16 v[0:15], v[196:199], v[116:119], v[0:15]
    ds_read_b64_tr_b16 v[188:189], v214 offset:10304
    ds_read_b64_tr_b16 v[190:191], v214 offset:12864
    s_waitcnt lgkmcnt(10)
    v_mfma_f32_32x32x16_bf16 v[16:31], v[200:203], v[116:119], v[16:31]
    ds_read_b64_tr_b16 v[192:193], v214 offset:10368
    ds_read_b64_tr_b16 v[194:195], v214 offset:12928
    s_waitcnt lgkmcnt(10)
    v_mfma_f32_32x32x16_bf16 v[32:47], v[204:207], v[116:119], v[32:47]
    ds_read_b64_tr_b16 v[196:197], v214 offset:10432
    ds_read_b64_tr_b16 v[198:199], v214 offset:12992
    s_waitcnt lgkmcnt(10)
    v_mfma_f32_32x32x16_bf16 v[48:63], v[176:179], v[116:119], v[48:63]
    ds_read_b64_tr_b16 v[200:201], v214 offset:10496
    ds_read_b64_tr_b16 v[202:203], v214 offset:13056
    s_waitcnt lgkmcnt(10)
    v_mfma_f32_32x32x16_bf16 v[64:79], v[180:183], v[116:119], v[64:79]
    ds_read_b64_tr_b16 v[204:205], v214 offset:15360
    ds_read_b64_tr_b16 v[206:207], v214 offset:17920
    s_waitcnt lgkmcnt(10)
    v_mfma_f32_32x32x16_bf16 v[0:15], v[184:187], v[120:123], v[0:15]
    ds_read_b64_tr_b16 v[176:177], v214 offset:15424
    ds_read_b64_tr_b16 v[178:179], v214 offset:17984
    s_waitcnt lgkmcnt(10)
    v_mfma_f32_32x32x16_bf16 v[16:31], v[188:191], v[120:123], v[16:31]
    ds_read_b64_tr_b16 v[180:181], v214 offset:15488
    ds_read_b64_tr_b16 v[182:183], v214 offset:18048
    s_waitcnt lgkmcnt(10)
    v_mfma_f32_32x32x16_bf16 v[32:47], v[192:195], v[120:123], v[32:47]
    ds_read_b64_tr_b16 v[184:185], v214 offset:15552
    ds_read_b64_tr_b16 v[186:187], v214 offset:18112
    s_waitcnt lgkmcnt(10)
    v_mfma_f32_32x32x16_bf16 v[48:63], v[196:199], v[120:123], v[48:63]
    ds_read_b64_tr_b16 v[188:189], v214 offset:15616
    ds_read_b64_tr_b16 v[190:191], v214 offset:18176
    s_waitcnt lgkmcnt(10)
    v_mfma_f32_32x32x16_bf16 v[64:79], v[200:203], v[120:123], v[64:79]
    ds_read_b64_tr_b16 v[192:193], v214 offset:20480
    ds_read_b64_tr_b16 v[194:195], v214 offset:23040
    s_waitcnt lgkmcnt(10)
    v_mfma_f32_32x32x16_bf16 v[0:15], v[204:207], v[124:127], v[0:15]
    ds_read_b64_tr_b16 v[196:197], v214 offset:20544
    ds_read_b64_tr_b16 v[198:199], v214 offset:23104
    s_waitcnt lgkmcnt(10)
    v_mfma_f32_32x32x16_bf16 v[16:31], v[176:179], v[124:127], v[16:31]
    ds_read_b64_tr_b16 v[200:201], v214 offset:20608
    ds_read_b64_tr_b16 v[202:203], v214 offset:23168
    s_waitcnt lgkmcnt(10)
    v_mfma_f32_32x32x16_bf16 v[32:47], v[180:183], v[124:127], v[32:47]
    ds_read_b64_tr_b16 v[204:205], v214 offset:20672
    ds_read_b64_tr_b16 v[206:207], v214 offset:23232
    s_waitcnt lgkmcnt(10)
    v_mfma_f32_32x32x16_bf16 v[48:63], v[184:187], v[124:127], v[48:63]
    ds_read_b64_tr_b16 v[176:177], v214 offset:20736
    ds_read_b64_tr_b16 v[178:179], v214 offset:23296
    s_waitcnt lgkmcnt(10)
    v_mfma_f32_32x32x16_bf16 v[64:79], v[188:191], v[124:127], v[64:79]
    ds_read_b64_tr_b16 v[180:181], v214 offset:25600
    ds_read_b64_tr_b16 v[182:183], v214 offset:28160
    s_waitcnt lgkmcnt(10)
    v_mfma_f32_32x32x16_bf16 v[0:15], v[192:195], v[128:131], v[0:15]
    ds_read_b64_tr_b16 v[184:185], v214 offset:25664
    ds_read_b64_tr_b16 v[186:187], v214 offset:28224
    s_waitcnt lgkmcnt(10)
    v_mfma_f32_32x32x16_bf16 v[16:31], v[196:199], v[128:131], v[16:31]
    ds_read_b64_tr_b16 v[188:189], v214 offset:25728
    ds_read_b64_tr_b16 v[190:191], v214 offset:28288
    s_waitcnt lgkmcnt(10)
    v_mfma_f32_32x32x16_bf16 v[32:47], v[200:203], v[128:131], v[32:47]
    ds_read_b64_tr_b16 v[192:193], v214 offset:25792
    ds_read_b64_tr_b16 v[194:195], v214 offset:28352
    s_waitcnt lgkmcnt(10)
    v_mfma_f32_32x32x16_bf16 v[48:63], v[204:207], v[128:131], v[48:63]
    ds_read_b64_tr_b16 v[196:197], v214 offset:25856
    ds_read_b64_tr_b16 v[198:199], v214 offset:28416
    s_waitcnt lgkmcnt(10)
    v_mfma_f32_32x32x16_bf16 v[64:79], v[176:179], v[128:131], v[64:79]
    ds_read_b64_tr_b16 v[200:201], v214 offset:30720
    ds_read_b64_tr_b16 v[202:203], v214 offset:33280
    s_waitcnt lgkmcnt(10)
    v_mfma_f32_32x32x16_bf16 v[0:15], v[180:183], v[132:135], v[0:15]
    ds_read_b64_tr_b16 v[204:205], v214 offset:30784
    ds_read_b64_tr_b16 v[206:207], v214 offset:33344
    s_waitcnt lgkmcnt(10)
    v_mfma_f32_32x32x16_bf16 v[16:31], v[184:187], v[132:135], v[16:31]
    ds_read_b64_tr_b16 v[176:177], v214 offset:30848
    ds_read_b64_tr_b16 v[178:179], v214 offset:33408
    s_waitcnt lgkmcnt(10)
    v_mfma_f32_32x32x16_bf16 v[32:47], v[188:191], v[132:135], v[32:47]
    ds_read_b64_tr_b16 v[180:181], v214 offset:30912
    ds_read_b64_tr_b16 v[182:183], v214 offset:33472
    s_waitcnt lgkmcnt(10)
    v_mfma_f32_32x32x16_bf16 v[48:63], v[192:195], v[132:135], v[48:63]
    ds_read_b64_tr_b16 v[184:185], v214 offset:30976
    ds_read_b64_tr_b16 v[186:187], v214 offset:33536
    s_waitcnt lgkmcnt(10)
    v_mfma_f32_32x32x16_bf16 v[64:79], v[196:199], v[132:135], v[64:79]
    ds_read_b64_tr_b16 v[188:189], v214 offset:35840
    ds_read_b64_tr_b16 v[190:191], v214 offset:38400
    s_waitcnt lgkmcnt(10)
    v_mfma_f32_32x32x16_bf16 v[0:15], v[200:203], v[136:139], v[0:15]
    ds_read_b64_tr_b16 v[192:193], v214 offset:35904
    ds_read_b64_tr_b16 v[194:195], v214 offset:38464
    s_waitcnt lgkmcnt(10)
    v_mfma_f32_32x32x16_bf16 v[16:31], v[204:207], v[136:139], v[16:31]
    ds_read_b64_tr_b16 v[196:197], v214 offset:35968
    ds_read_b64_tr_b16 v[198:199], v214 offset:38528
    s_waitcnt lgkmcnt(10)
    v_mfma_f32_32x32x16_bf16 v[32:47], v[176:179], v[136:139], v[32:47]
    ds_read_b64_tr_b16 v[200:201], v214 offset:36032
    ds_read_b64_tr_b16 v[202:203], v214 offset:38592
    s_waitcnt lgkmcnt(10)
    v_mfma_f32_32x32x16_bf16 v[48:63], v[180:183], v[136:139], v[48:63]
    ds_read_b64_tr_b16 v[204:205], v214 offset:36096
    ds_read_b64_tr_b16 v[206:207], v214 offset:38656
    s_waitcnt lgkmcnt(10)
    v_mfma_f32_32x32x16_bf16 v[64:79], v[184:187], v[136:139], v[64:79]
    s_waitcnt lgkmcnt(8)
    v_mfma_f32_32x32x16_bf16 v[0:15], v[188:191], v[140:143], v[0:15]
    s_waitcnt lgkmcnt(6)
    v_mfma_f32_32x32x16_bf16 v[16:31], v[192:195], v[140:143], v[16:31]
    s_waitcnt lgkmcnt(4)
    v_mfma_f32_32x32x16_bf16 v[32:47], v[196:199], v[140:143], v[32:47]
    s_waitcnt lgkmcnt(2)
    v_mfma_f32_32x32x16_bf16 v[48:63], v[200:203], v[140:143], v[48:63]
    s_waitcnt lgkmcnt(0)
    v_mfma_f32_32x32x16_bf16 v[64:79], v[204:207], v[140:143], v[64:79]
    s_waitcnt vmcnt(0)
    s_barrier
    ds_read_b64_tr_b16 v[176:177], v215 offset:0
    ds_read_b64_tr_b16 v[178:179], v215 offset:2560
    ds_read_b64_tr_b16 v[180:181], v215 offset:64
    ds_read_b64_tr_b16 v[182:183], v215 offset:2624
    ds_read_b64_tr_b16 v[184:185], v215 offset:128
    ds_read_b64_tr_b16 v[186:187], v215 offset:2688
    ds_read_b64_tr_b16 v[188:189], v215 offset:192
    ds_read_b64_tr_b16 v[190:191], v215 offset:2752
    ds_read_b64_tr_b16 v[192:193], v215 offset:256
    ds_read_b64_tr_b16 v[194:195], v215 offset:2816
    ds_read_b64_tr_b16 v[196:197], v215 offset:5120
    ds_read_b64_tr_b16 v[198:199], v215 offset:7680
    s_waitcnt lgkmcnt(10)
    v_mfma_f32_32x32x16_bf16 v[0:15], v[176:179], v[144:147], v[0:15]
    ds_read_b64_tr_b16 v[200:201], v215 offset:5184
    ds_read_b64_tr_b16 v[202:203], v215 offset:7744
    s_waitcnt lgkmcnt(10)
    v_mfma_f32_32x32x16_bf16 v[16:31], v[180:183], v[144:147], v[16:31]
    ds_read_b64_tr_b16 v[204:205], v215 offset:5248
    ds_read_b64_tr_b16 v[206:207], v215 offset:7808
    s_waitcnt lgkmcnt(10)
    v_mfma_f32_32x32x16_bf16 v[32:47], v[184:187], v[144:147], v[32:47]
    ds_read_b64_tr_b16 v[176:177], v215 offset:5312
    ds_read_b64_tr_b16 v[178:179], v215 offset:7872
    s_waitcnt lgkmcnt(10)
    v_mfma_f32_32x32x16_bf16 v[48:63], v[188:191], v[144:147], v[48:63]
    ds_read_b64_tr_b16 v[180:181], v215 offset:5376
    ds_read_b64_tr_b16 v[182:183], v215 offset:7936
    s_waitcnt lgkmcnt(10)
    v_mfma_f32_32x32x16_bf16 v[64:79], v[192:195], v[144:147], v[64:79]
    ds_read_b64_tr_b16 v[184:185], v215 offset:10240
    ds_read_b64_tr_b16 v[186:187], v215 offset:12800
    s_waitcnt lgkmcnt(10)
    v_mfma_f32_32x32x16_bf16 v[0:15], v[196:199], v[148:151], v[0:15]
    ds_read_b64_tr_b16 v[188:189], v215 offset:10304
    ds_read_b64_tr_b16 v[190:191], v215 offset:12864
    s_waitcnt lgkmcnt(10)
    v_mfma_f32_32x32x16_bf16 v[16:31], v[200:203], v[148:151], v[16:31]
    ds_read_b64_tr_b16 v[192:193], v215 offset:10368
    ds_read_b64_tr_b16 v[194:195], v215 offset:12928
    s_waitcnt lgkmcnt(10)
    v_mfma_f32_32x32x16_bf16 v[32:47], v[204:207], v[148:151], v[32:47]
    ds_read_b64_tr_b16 v[196:197], v215 offset:10432
    ds_read_b64_tr_b16 v[198:199], v215 offset:12992
    s_waitcnt lgkmcnt(10)
    v_mfma_f32_32x32x16_bf16 v[48:63], v[176:179], v[148:151], v[48:63]
    ds_read_b64_tr_b16 v[200:201], v215 offset:10496
    ds_read_b64_tr_b16 v[202:203], v215 offset:13056
    s_waitcnt lgkmcnt(10)
    v_mfma_f32_32x32x16_bf16 v[64:79], v[180:183], v[148:151], v[64:79]
    ds_read_b64_tr_b16 v[204:205], v215 offset:15360
    ds_read_b64_tr_b16 v[206:207], v215 offset:17920
    s_waitcnt lgkmcnt(10)
    v_mfma_f32_32x32x16_bf16 v[0:15], v[184:187], v[152:155], v[0:15]
    ds_read_b64_tr_b16 v[176:177], v215 offset:15424
    ds_read_b64_tr_b16 v[178:179], v215 offset:17984
    s_waitcnt lgkmcnt(10)
    v_mfma_f32_32x32x16_bf16 v[16:31], v[188:191], v[152:155], v[16:31]
    ds_read_b64_tr_b16 v[180:181], v215 offset:15488
    ds_read_b64_tr_b16 v[182:183], v215 offset:18048
    s_waitcnt lgkmcnt(10)
    v_mfma_f32_32x32x16_bf16 v[32:47], v[192:195], v[152:155], v[32:47]
    ds_read_b64_tr_b16 v[184:185], v215 offset:15552
    ds_read_b64_tr_b16 v[186:187], v215 offset:18112
    s_waitcnt lgkmcnt(10)
    v_mfma_f32_32x32x16_bf16 v[48:63], v[196:199], v[152:155], v[48:63]
    ds_read_b64_tr_b16 v[188:189], v215 offset:15616
    ds_read_b64_tr_b16 v[190:191], v215 offset:18176
    s_waitcnt lgkmcnt(10)
    v_mfma_f32_32x32x16_bf16 v[64:79], v[200:203], v[152:155], v[64:79]
    ds_read_b64_tr_b16 v[192:193], v215 offset:20480
    ds_read_b64_tr_b16 v[194:195], v215 offset:23040
    s_waitcnt lgkmcnt(10)
    v_mfma_f32_32x32x16_bf16 v[0:15], v[204:207], v[156:159], v[0:15]
    ds_read_b64_tr_b16 v[196:197], v215 offset:20544
    ds_read_b64_tr_b16 v[198:199], v215 offset:23104
    s_waitcnt lgkmcnt(10)
    v_mfma_f32_32x32x16_bf16 v[16:31], v[176:179], v[156:159], v[16:31]
    ds_read_b64_tr_b16 v[200:201], v215 offset:20608
    ds_read_b64_tr_b16 v[202:203], v215 offset:23168
    s_waitcnt lgkmcnt(10)
    v_mfma_f32_32x32x16_bf16 v[32:47], v[180:183], v[156:159], v[32:47]
    ds_read_b64_tr_b16 v[204:205], v215 offset:20672
    ds_read_b64_tr_b16 v[206:207], v215 offset:23232
    s_waitcnt lgkmcnt(10)
    v_mfma_f32_32x32x16_bf16 v[48:63], v[184:187], v[156:159], v[48:63]
    ds_read_b64_tr_b16 v[176:177], v215 offset:20736
    ds_read_b64_tr_b16 v[178:179], v215 offset:23296
    s_waitcnt lgkmcnt(10)
    v_mfma_f32_32x32x16_bf16 v[64:79], v[188:191], v[156:159], v[64:79]
    ds_read_b64_tr_b16 v[180:181], v215 offset:25600
    ds_read_b64_tr_b16 v[182:183], v215 offset:28160
    s_waitcnt lgkmcnt(10)
    v_mfma_f32_32x32x16_bf16 v[0:15], v[192:195], v[160:163], v[0:15]
    ds_read_b64_tr_b16 v[184:185], v215 offset:25664
    ds_read_b64_tr_b16 v[186:187], v215 offset:28224
    s_waitcnt lgkmcnt(10)
    v_mfma_f32_32x32x16_bf16 v[16:31], v[196:199], v[160:163], v[16:31]
    ds_read_b64_tr_b16 v[188:189], v215 offset:25728
    ds_read_b64_tr_b16 v[190:191], v215 offset:28288
    s_waitcnt lgkmcnt(10)
    v_mfma_f32_32x32x16_bf16 v[32:47], v[200:203], v[160:163], v[32:47]
    ds_read_b64_tr_b16 v[192:193], v215 offset:25792
    ds_read_b64_tr_b16 v[194:195], v215 offset:28352
    s_waitcnt lgkmcnt(10)
    v_mfma_f32_32x32x16_bf16 v[48:63], v[204:207], v[160:163], v[48:63]
    ds_read_b64_tr_b16 v[196:197], v215 offset:25856
    ds_read_b64_tr_b16 v[198:199], v215 offset:28416
    s_waitcnt lgkmcnt(10)
    v_mfma_f32_32x32x16_bf16 v[64:79], v[176:179], v[160:163], v[64:79]
    ds_read_b64_tr_b16 v[200:201], v215 offset:30720
    ds_read_b64_tr_b16 v[202:203], v215 offset:33280
    s_waitcnt lgkmcnt(10)
    v_mfma_f32_32x32x16_bf16 v[0:15], v[180:183], v[164:167], v[0:15]
    ds_read_b64_tr_b16 v[204:205], v215 offset:30784
    ds_read_b64_tr_b16 v[206:207], v215 offset:33344
    s_waitcnt lgkmcnt(10)
    v_mfma_f32_32x32x16_bf16 v[16:31], v[184:187], v[164:167], v[16:31]
    ds_read_b64_tr_b16 v[176:177], v215 offset:30848
    ds_read_b64_tr_b16 v[178:179], v215 offset:33408
    s_waitcnt lgkmcnt(10)
    v_mfma_f32_32x32x16_bf16 v[32:47], v[188:191], v[164:167], v[32:47]
    ds_read_b64_tr_b16 v[180:181], v215 offset:30912
    ds_read_b64_tr_b16 v[182:183], v215 offset:33472
    s_waitcnt lgkmcnt(10)
    v_mfma_f32_32x32x16_bf16 v[48:63], v[192:195], v[164:167], v[48:63]
    ds_read_b64_tr_b16 v[184:185], v215 offset:30976
    ds_read_b64_tr_b16 v[186:187], v215 offset:33536
    s_waitcnt lgkmcnt(10)
    v_mfma_f32_32x32x16_bf16 v[64:79], v[196:199], v[164:167], v[64:79]
    ds_read_b64_tr_b16 v[188:189], v215 offset:35840
    ds_read_b64_tr_b16 v[190:191], v215 offset:38400
    s_waitcnt lgkmcnt(10)
    v_mfma_f32_32x32x16_bf16 v[0:15], v[200:203], v[168:171], v[0:15]
    ds_read_b64_tr_b16 v[192:193], v215 offset:35904
    ds_read_b64_tr_b16 v[194:195], v215 offset:38464
    s_waitcnt lgkmcnt(10)
    v_mfma_f32_32x32x16_bf16 v[16:31], v[204:207], v[168:171], v[16:31]
    ds_read_b64_tr_b16 v[196:197], v215 offset:35968
    ds_read_b64_tr_b16 v[198:199], v215 offset:38528
    s_waitcnt lgkmcnt(10)
    v_mfma_f32_32x32x16_bf16 v[32:47], v[176:179], v[168:171], v[32:47]
    ds_read_b64_tr_b16 v[200:201], v215 offset:36032
    ds_read_b64_tr_b16 v[202:203], v215 offset:38592
    s_waitcnt lgkmcnt(10)
    v_mfma_f32_32x32x16_bf16 v[48:63], v[180:183], v[168:171], v[48:63]
    ds_read_b64_tr_b16 v[204:205], v215 offset:36096
    ds_read_b64_tr_b16 v[206:207], v215 offset:38656
    s_waitcnt lgkmcnt(10)
    v_mfma_f32_32x32x16_bf16 v[64:79], v[184:187], v[168:171], v[64:79]
    s_waitcnt lgkmcnt(8)
    v_mfma_f32_32x32x16_bf16 v[0:15], v[188:191], v[172:175], v[0:15]
    s_waitcnt lgkmcnt(6)
    v_mfma_f32_32x32x16_bf16 v[16:31], v[192:195], v[172:175], v[16:31]
    s_waitcnt lgkmcnt(4)
    v_mfma_f32_32x32x16_bf16 v[32:47], v[196:199], v[172:175], v[32:47]
    s_waitcnt lgkmcnt(2)
    v_mfma_f32_32x32x16_bf16 v[48:63], v[200:203], v[172:175], v[48:63]
    s_waitcnt lgkmcnt(0)
    v_mfma_f32_32x32x16_bf16 v[64:79], v[204:207], v[172:175], v[64:79]
    s_nop 7
    s_nop 3
    v_cvt_pk_bf16_f32 v80, v0, v1
    v_cvt_pk_bf16_f32 v81, v2, v3
    v_cvt_pk_bf16_f32 v82, v4, v5
    v_cvt_pk_bf16_f32 v83, v6, v7
    v_cvt_pk_bf16_f32 v84, v8, v9
    v_cvt_pk_bf16_f32 v85, v10, v11
    v_cvt_pk_bf16_f32 v86, v12, v13
    v_cvt_pk_bf16_f32 v87, v14, v15
    s_mov_b32 s29, 0
    buffer_store_dwordx4 v[80:83], v216, s[12:15], s29 offen offset:0 sc1
    buffer_store_dwordx4 v[84:87], v216, s[12:15], s29 offen offset:1024 sc1
    v_cvt_pk_bf16_f32 v88, v16, v17
    v_cvt_pk_bf16_f32 v89, v18, v19
    v_cvt_pk_bf16_f32 v90, v20, v21
    v_cvt_pk_bf16_f32 v91, v22, v23
    v_cvt_pk_bf16_f32 v92, v24, v25
    v_cvt_pk_bf16_f32 v93, v26, v27
    v_cvt_pk_bf16_f32 v94, v28, v29
    v_cvt_pk_bf16_f32 v95, v30, v31
    s_mov_b32 s29, 2048
    buffer_store_dwordx4 v[88:91], v216, s[12:15], s29 offen offset:0 sc1
    buffer_store_dwordx4 v[92:95], v216, s[12:15], s29 offen offset:1024 sc1
    v_cvt_pk_bf16_f32 v96, v32, v33
    v_cvt_pk_bf16_f32 v97, v34, v35
    v_cvt_pk_bf16_f32 v98, v36, v37
    v_cvt_pk_bf16_f32 v99, v38, v39
    v_cvt_pk_bf16_f32 v100, v40, v41
    v_cvt_pk_bf16_f32 v101, v42, v43
    v_cvt_pk_bf16_f32 v102, v44, v45
    v_cvt_pk_bf16_f32 v103, v46, v47
    s_mov_b32 s29, 4096
    buffer_store_dwordx4 v[96:99], v216, s[12:15], s29 offen offset:0 sc1
    buffer_store_dwordx4 v[100:103], v216, s[12:15], s29 offen offset:1024 sc1
    v_cvt_pk_bf16_f32 v104, v48, v49
    v_cvt_pk_bf16_f32 v105, v50, v51
    v_cvt_pk_bf16_f32 v106, v52, v53
    v_cvt_pk_bf16_f32 v107, v54, v55
    v_cvt_pk_bf16_f32 v108, v56, v57
    v_cvt_pk_bf16_f32 v109, v58, v59
    v_cvt_pk_bf16_f32 v110, v60, v61
    v_cvt_pk_bf16_f32 v111, v62, v63
    s_mov_b32 s29, 6144
    buffer_store_dwordx4 v[104:107], v216, s[12:15], s29 offen offset:0 sc1
    buffer_store_dwordx4 v[108:111], v216, s[12:15], s29 offen offset:1024 sc1
    v_cvt_pk_bf16_f32 v112, v64, v65
    v_cvt_pk_bf16_f32 v113, v66, v67
    v_cvt_pk_bf16_f32 v114, v68, v69
    v_cvt_pk_bf16_f32 v115, v70, v71
    v_cvt_pk_bf16_f32 v116, v72, v73
    v_cvt_pk_bf16_f32 v117, v74, v75
    v_cvt_pk_bf16_f32 v118, v76, v77
    v_cvt_pk_bf16_f32 v119, v78, v79
    s_mov_b32 s29, 8192
    buffer_store_dwordx4 v[112:115], v216, s[12:15], s29 offen offset:0 sc1
    buffer_store_dwordx4 v[116:119], v216, s[12:15], s29 offen offset:1024 sc1
K2_END:
    s_endpgm
.globl mha_comb_kernel
.p2align 8
.type mha_comb_kernel,@function
mha_comb_kernel:
    s_cmp_ge_u32 s2, 256
    s_cbranch_scc1 K3_END
    s_load_dwordx2 s[32:33], s[0:1], 80
    s_load_dwordx2 s[36:37], s[0:1], 96
    v_lshrrev_b32 v1, 6, v0
    v_and_b32 v2, 63, v0
    s_nop 0
    v_readfirstlane_b32 s24, v1
    s_mul_i32 s25, s2, 5
    s_add_u32 s25, s25, s24
    s_mul_hi_u32 s26, s25, 0x33333334
    s_mul_i32 s27, s26, 5
    s_sub_u32 s27, s25, s27
    s_and_b32 s28, s26, 3
    s_lshr_b32 s29, s26, 2
    s_and_b32 s29, s29, 3
    s_lshr_b32 s30, s26, 4
    s_and_b32 s30, s30, 7
    s_lshr_b32 s31, s26, 7
    s_waitcnt lgkmcnt(0)
    s_lshl_b32 s40, s25, 11
    s_add_u32 s40, s40, 25165824
    s_add_u32 s36, s36, s40
    s_addc_u32 s37, s37, 0
    s_mov_b32 s4, s36
    s_and_b32 s5, s37, 0xffff
    s_mov_b32 s6, 18352128
    s_mov_b32 s7, 0x20000
    s_mov_b32 s8, s32
    s_and_b32 s9, s33, 0xffff
    s_mov_b32 s10, 2621440
    s_mov_b32 s11, 0x20000
    v_lshlrev_b32 v3, 4, v2
    s_mov_b32 s41, 0
    buffer_load_dwordx4 v[8:11], v3, s[4:7], s41 offen offset:0
    buffer_load_dwordx4 v[12:15], v3, s[4:7], s41 offen offset:1024
    s_mov_b32 s42, 2621440
    buffer_load_dwordx4 v[16:19], v3, s[4:7], s42 offen offset:0
    buffer_load_dwordx4 v[20:23], v3, s[4:7], s42 offen offset:1024
    s_mov_b32 s43, 5242880
    buffer_load_dwordx4 v[24:27], v3, s[4:7], s43 offen offset:0
    buffer_load_dwordx4 v[28:31], v3, s[4:7], s43 offen offset:1024
    s_mov_b32 s44, 7864320
    buffer_load_dwordx4 v[32:35], v3, s[4:7], s44 offen offset:0
    buffer_load_dwordx4 v[36:39], v3, s[4:7], s44 offen offset:1024
    s_mov_b32 s45, 10485760
    buffer_load_dwordx4 v[40:43], v3, s[4:7], s45 offen offset:0
    buffer_load_dwordx4 v[44:47], v3, s[4:7], s45 offen offset:1024
    s_mov_b32 s46, 13107200
    buffer_load_dwordx4 v[48:51], v3, s[4:7], s46 offen offset:0
    buffer_load_dwordx4 v[52:55], v3, s[4:7], s46 offen offset:1024
    s_mov_b32 s47, 15728640
    buffer_load_dwordx4 v[56:59], v3, s[4:7], s47 offen offset:0
    buffer_load_dwordx4 v[60:63], v3, s[4:7], s47 offen offset:1024
    s_mov_b32 s48, 18350080
    buffer_load_dwordx4 v[64:67], v3, s[4:7], s48 offen offset:0
    buffer_load_dwordx4 v[68:71], v3, s[4:7], s48 offen offset:1024
    s_lshl_b32 s40, s30, 7
    s_lshl_b32 s50, s28, 5
    s_add_u32 s40, s40, s50
    s_mul_i32 s40, s40, 2560
    s_mul_i32 s50, s31, 1280
    s_add_u32 s40, s40, s50
    s_mul_i32 s50, s29, 320
    s_add_u32 s40, s40, s50
    s_lshl_b32 s50, s27, 6
    s_add_u32 s40, s40, s50
    v_and_b32 v4, 31, v2
    v_mul_u32_u24 v4, 2560, v4
    v_lshrrev_b32 v5, 5, v2
    v_lshlrev_b32 v5, 3, v5
    v_add_u32 v4, v4, v5
    v_add_u32 v4, s40, v4
    s_waitcnt vmcnt(14)
    v_lshlrev_b32 v72, 16, v8
    v_and_b32 v80, 0xffff0000, v8
    v_lshlrev_b32 v73, 16, v9
    v_and_b32 v81, 0xffff0000, v9
    v_lshlrev_b32 v74, 16, v10
    v_and_b32 v82, 0xffff0000, v10
    v_lshlrev_b32 v75, 16, v11
    v_and_b32 v83, 0xffff0000, v11
    v_lshlrev_b32 v76, 16, v12
    v_and_b32 v84, 0xffff0000, v12
    v_lshlrev_b32 v77, 16, v13
    v_and_b32 v85, 0xffff0000, v13
    v_lshlrev_b32 v78, 16, v14
    v_and_b32 v86, 0xffff0000, v14
    v_lshlrev_b32 v79, 16, v15
    v_and_b32 v87, 0xffff0000, v15
    s_waitcnt vmcnt(12)
    v_lshlrev_b32 v6, 16, v16
    v_and_b32 v7, 0xffff0000, v16
    v_add_f32 v72, v72, v6
    v_add_f32 v80, v80, v7
    v_lshlrev_b32 v6, 16, v17
    v_and_b32 v7, 0xffff0000, v17
    v_add_f32 v73, v73, v6
    v_add_f32 v81, v81, v7
    v_lshlrev_b32 v6, 16, v18
    v_and_b32 v7, 0xffff0000, v18
    v_add_f32 v74, v74, v6
    v_add_f32 v82, v82, v7
    v_lshlrev_b32 v6, 16, v19
    v_and_b32 v7, 0xffff0000, v19
    v_add_f32 v75, v75, v6
    v_add_f32 v83, v83, v7
    v_lshlrev_b32 v6, 16, v20
    v_and_b32 v7, 0xffff0000, v20
    v_add_f32 v76, v76, v6
    v_add_f32 v84, v84, v7
    v_lshlrev_b32 v6, 16, v21
    v_and_b32 v7, 0xffff0000, v21
    v_add_f32 v77, v77, v6
    v_add_f32 v85, v85, v7
    v_lshlrev_b32 v6, 16, v22
    v_and_b32 v7, 0xffff0000, v22
    v_add_f32 v78, v78, v6
    v_add_f32 v86, v86, v7
    v_lshlrev_b32 v6, 16, v23
    v_and_b32 v7, 0xffff0000, v23
    v_add_f32 v79, v79, v6
    v_add_f32 v87, v87, v7
    s_waitcnt vmcnt(10)
    v_lshlrev_b32 v6, 16, v24
    v_and_b32 v7, 0xffff0000, v24
    v_add_f32 v72, v72, v6
    v_add_f32 v80, v80, v7
    v_lshlrev_b32 v6, 16, v25
    v_and_b32 v7, 0xffff0000, v25
    v_add_f32 v73, v73, v6
    v_add_f32 v81, v81, v7
    v_lshlrev_b32 v6, 16, v26
    v_and_b32 v7, 0xffff0000, v26
    v_add_f32 v74, v74, v6
    v_add_f32 v82, v82, v7
    v_lshlrev_b32 v6, 16, v27
    v_and_b32 v7, 0xffff0000, v27
    v_add_f32 v75, v75, v6
    v_add_f32 v83, v83, v7
    v_lshlrev_b32 v6, 16, v28
    v_and_b32 v7, 0xffff0000, v28
    v_add_f32 v76, v76, v6
    v_add_f32 v84, v84, v7
    v_lshlrev_b32 v6, 16, v29
    v_and_b32 v7, 0xffff0000, v29
    v_add_f32 v77, v77, v6
    v_add_f32 v85, v85, v7
    v_lshlrev_b32 v6, 16, v30
    v_and_b32 v7, 0xffff0000, v30
    v_add_f32 v78, v78, v6
    v_add_f32 v86, v86, v7
    v_lshlrev_b32 v6, 16, v31
    v_and_b32 v7, 0xffff0000, v31
    v_add_f32 v79, v79, v6
    v_add_f32 v87, v87, v7
    s_waitcnt vmcnt(8)
    v_lshlrev_b32 v6, 16, v32
    v_and_b32 v7, 0xffff0000, v32
    v_add_f32 v72, v72, v6
    v_add_f32 v80, v80, v7
    v_lshlrev_b32 v6, 16, v33
    v_and_b32 v7, 0xffff0000, v33
    v_add_f32 v73, v73, v6
    v_add_f32 v81, v81, v7
    v_lshlrev_b32 v6, 16, v34
    v_and_b32 v7, 0xffff0000, v34
    v_add_f32 v74, v74, v6
    v_add_f32 v82, v82, v7
    v_lshlrev_b32 v6, 16, v35
    v_and_b32 v7, 0xffff0000, v35
    v_add_f32 v75, v75, v6
    v_add_f32 v83, v83, v7
    v_lshlrev_b32 v6, 16, v36
    v_and_b32 v7, 0xffff0000, v36
    v_add_f32 v76, v76, v6
    v_add_f32 v84, v84, v7
    v_lshlrev_b32 v6, 16, v37
    v_and_b32 v7, 0xffff0000, v37
    v_add_f32 v77, v77, v6
    v_add_f32 v85, v85, v7
    v_lshlrev_b32 v6, 16, v38
    v_and_b32 v7, 0xffff0000, v38
    v_add_f32 v78, v78, v6
    v_add_f32 v86, v86, v7
    v_lshlrev_b32 v6, 16, v39
    v_and_b32 v7, 0xffff0000, v39
    v_add_f32 v79, v79, v6
    v_add_f32 v87, v87, v7
    s_waitcnt vmcnt(6)
    v_lshlrev_b32 v6, 16, v40
    v_and_b32 v7, 0xffff0000, v40
    v_add_f32 v72, v72, v6
    v_add_f32 v80, v80, v7
    v_lshlrev_b32 v6, 16, v41
    v_and_b32 v7, 0xffff0000, v41
    v_add_f32 v73, v73, v6
    v_add_f32 v81, v81, v7
    v_lshlrev_b32 v6, 16, v42
    v_and_b32 v7, 0xffff0000, v42
    v_add_f32 v74, v74, v6
    v_add_f32 v82, v82, v7
    v_lshlrev_b32 v6, 16, v43
    v_and_b32 v7, 0xffff0000, v43
    v_add_f32 v75, v75, v6
    v_add_f32 v83, v83, v7
    v_lshlrev_b32 v6, 16, v44
    v_and_b32 v7, 0xffff0000, v44
    v_add_f32 v76, v76, v6
    v_add_f32 v84, v84, v7
    v_lshlrev_b32 v6, 16, v45
    v_and_b32 v7, 0xffff0000, v45
    v_add_f32 v77, v77, v6
    v_add_f32 v85, v85, v7
    v_lshlrev_b32 v6, 16, v46
    v_and_b32 v7, 0xffff0000, v46
    v_add_f32 v78, v78, v6
    v_add_f32 v86, v86, v7
    v_lshlrev_b32 v6, 16, v47
    v_and_b32 v7, 0xffff0000, v47
    v_add_f32 v79, v79, v6
    v_add_f32 v87, v87, v7
    s_waitcnt vmcnt(4)
    v_lshlrev_b32 v6, 16, v48
    v_and_b32 v7, 0xffff0000, v48
    v_add_f32 v72, v72, v6
    v_add_f32 v80, v80, v7
    v_lshlrev_b32 v6, 16, v49
    v_and_b32 v7, 0xffff0000, v49
    v_add_f32 v73, v73, v6
    v_add_f32 v81, v81, v7
    v_lshlrev_b32 v6, 16, v50
    v_and_b32 v7, 0xffff0000, v50
    v_add_f32 v74, v74, v6
    v_add_f32 v82, v82, v7
    v_lshlrev_b32 v6, 16, v51
    v_and_b32 v7, 0xffff0000, v51
    v_add_f32 v75, v75, v6
    v_add_f32 v83, v83, v7
    v_lshlrev_b32 v6, 16, v52
    v_and_b32 v7, 0xffff0000, v52
    v_add_f32 v76, v76, v6
    v_add_f32 v84, v84, v7
    v_lshlrev_b32 v6, 16, v53
    v_and_b32 v7, 0xffff0000, v53
    v_add_f32 v77, v77, v6
    v_add_f32 v85, v85, v7
    v_lshlrev_b32 v6, 16, v54
    v_and_b32 v7, 0xffff0000, v54
    v_add_f32 v78, v78, v6
    v_add_f32 v86, v86, v7
    v_lshlrev_b32 v6, 16, v55
    v_and_b32 v7, 0xffff0000, v55
    v_add_f32 v79, v79, v6
    v_add_f32 v87, v87, v7
    s_waitcnt vmcnt(2)
    v_lshlrev_b32 v6, 16, v56
    v_and_b32 v7, 0xffff0000, v56
    v_add_f32 v72, v72, v6
    v_add_f32 v80, v80, v7
    v_lshlrev_b32 v6, 16, v57
    v_and_b32 v7, 0xffff0000, v57
    v_add_f32 v73, v73, v6
    v_add_f32 v81, v81, v7
    v_lshlrev_b32 v6, 16, v58
    v_and_b32 v7, 0xffff0000, v58
    v_add_f32 v74, v74, v6
    v_add_f32 v82, v82, v7
    v_lshlrev_b32 v6, 16, v59
    v_and_b32 v7, 0xffff0000, v59
    v_add_f32 v75, v75, v6
    v_add_f32 v83, v83, v7
    v_lshlrev_b32 v6, 16, v60
    v_and_b32 v7, 0xffff0000, v60
    v_add_f32 v76, v76, v6
    v_add_f32 v84, v84, v7
    v_lshlrev_b32 v6, 16, v61
    v_and_b32 v7, 0xffff0000, v61
    v_add_f32 v77, v77, v6
    v_add_f32 v85, v85, v7
    v_lshlrev_b32 v6, 16, v62
    v_and_b32 v7, 0xffff0000, v62
    v_add_f32 v78, v78, v6
    v_add_f32 v86, v86, v7
    v_lshlrev_b32 v6, 16, v63
    v_and_b32 v7, 0xffff0000, v63
    v_add_f32 v79, v79, v6
    v_add_f32 v87, v87, v7
    s_waitcnt vmcnt(0)
    v_lshlrev_b32 v6, 16, v64
    v_and_b32 v7, 0xffff0000, v64
    v_add_f32 v72, v72, v6
    v_add_f32 v80, v80, v7
    v_lshlrev_b32 v6, 16, v65
    v_and_b32 v7, 0xffff0000, v65
    v_add_f32 v73, v73, v6
    v_add_f32 v81, v81, v7
    v_lshlrev_b32 v6, 16, v66
    v_and_b32 v7, 0xffff0000, v66
    v_add_f32 v74, v74, v6
    v_add_f32 v82, v82, v7
    v_lshlrev_b32 v6, 16, v67
    v_and_b32 v7, 0xffff0000, v67
    v_add_f32 v75, v75, v6
    v_add_f32 v83, v83, v7
    v_lshlrev_b32 v6, 16, v68
    v_and_b32 v7, 0xffff0000, v68
    v_add_f32 v76, v76, v6
    v_add_f32 v84, v84, v7
    v_lshlrev_b32 v6, 16, v69
    v_and_b32 v7, 0xffff0000, v69
    v_add_f32 v77, v77, v6
    v_add_f32 v85, v85, v7
    v_lshlrev_b32 v6, 16, v70
    v_and_b32 v7, 0xffff0000, v70
    v_add_f32 v78, v78, v6
    v_add_f32 v86, v86, v7
    v_lshlrev_b32 v6, 16, v71
    v_and_b32 v7, 0xffff0000, v71
    v_add_f32 v79, v79, v6
    v_add_f32 v87, v87, v7
    v_cvt_pk_bf16_f32 v88, v72, v80
    v_cvt_pk_bf16_f32 v89, v73, v81
    v_cvt_pk_bf16_f32 v90, v74, v82
    v_cvt_pk_bf16_f32 v91, v75, v83
    v_cvt_pk_bf16_f32 v92, v76, v84
    v_cvt_pk_bf16_f32 v93, v77, v85
    v_cvt_pk_bf16_f32 v94, v78, v86
    v_cvt_pk_bf16_f32 v95, v79, v87
    buffer_store_dwordx2 v[88:89], v4, s[8:11], 0 offen offset:0
    buffer_store_dwordx2 v[90:91], v4, s[8:11], 0 offen offset:16
    buffer_store_dwordx2 v[92:93], v4, s[8:11], 0 offen offset:32
    buffer_store_dwordx2 v[94:95], v4, s[8:11], 0 offen offset:48
K3_END:
    s_endpgm
.section .rodata,"a"
.p2align 6
.amdhsa_kernel concat_heads__mha_block_cached__mha_block_cached__near_ridge_kernel
  .amdhsa_next_free_vgpr 256
  .amdhsa_next_free_sgpr 102
  .amdhsa_accum_offset 256
  .amdhsa_group_segment_fixed_size 0
  .amdhsa_kernarg_size 104
  .amdhsa_user_sgpr_count 2
  .amdhsa_user_sgpr_kernarg_segment_ptr 1
  .amdhsa_system_sgpr_workgroup_id_x 1
.end_amdhsa_kernel
.p2align 6
.amdhsa_kernel mha_oproj_kernel
  .amdhsa_next_free_vgpr 225
  .amdhsa_next_free_sgpr 102
  .amdhsa_accum_offset 228
  .amdhsa_group_segment_fixed_size 0
  .amdhsa_kernarg_size 104
  .amdhsa_user_sgpr_count 2
  .amdhsa_user_sgpr_kernarg_segment_ptr 1
  .amdhsa_system_sgpr_workgroup_id_x 1
.end_amdhsa_kernel
.p2align 6
.amdhsa_kernel mha_comb_kernel
  .amdhsa_next_free_vgpr 96
  .amdhsa_next_free_sgpr 102
  .amdhsa_accum_offset 96
  .amdhsa_group_segment_fixed_size 0
  .amdhsa_kernarg_size 104
  .amdhsa_user_sgpr_count 2
  .amdhsa_user_sgpr_kernarg_segment_ptr 1
  .amdhsa_system_sgpr_workgroup_id_x 1
.end_amdhsa_kernel
```
